```python
import torch

def _softmax(x, axis=-1):
    return torch.softmax(x, dim=axis)
def _gelu(x):
    return torch.nn.functional.gelu(x, approximate="tanh")
def _silu(x):
    return torch.nn.functional.silu(x)
def _sigmoid(x):
    return torch.sigmoid(x)
def _layernorm(x, axis=-1, eps=1e-5):
    m = x.mean(dim=axis, keepdim=True)
    v = x.var(dim=axis, keepdim=True, unbiased=False)
    return (x - m) / torch.sqrt(v + eps)
def _scatter_add(tgt, idx, src, axis=0):
    return tgt.clone().index_add_(axis, idx, src)
def _segment_sum(src, seg, n):
    out = torch.zeros((n,) + src.shape[1:], dtype=src.dtype)
    return out.index_add_(0, seg, src)
def _pad(x, pw):
    flat = tuple(v for pair in reversed(pw) for v in pair)
    return torch.nn.functional.pad(x, flat)

kernel_name = 'recurrent_scan__sliding_block_cached__dense_activation_gelu__decode'

def setup_inputs():

    _w = (lambda a: (lambda t: t.to(torch.bfloat16) if t.is_floating_point() else t)(torch.as_tensor(a)))
    def _A_setup():
        B, Sq, D = 1, 1, 512
        Hq, Hkv, Sk, Dh = 32, 8, 32768, 128
        assert Hq % Hkv == 0, (Hq, Hkv)
        return {
            "x": _w((lambda *s: torch.randn(*s, dtype=torch.bfloat16) * 0.4)(B, Sq, D)),
            "k_cache": _w((lambda *s: torch.randn(*s, dtype=torch.bfloat16) * 1.6)(B, Hkv, Sk, Dh)),
            "v_cache": _w((lambda *s: torch.randn(*s, dtype=torch.bfloat16) * 1.6)(B, Hkv, Sk, Dh)),
            "wq": _w((lambda *s: torch.randn(*s, dtype=torch.bfloat16) * 1.6)(D, Hq * Dh) * (D ** -0.5)),
            "wo": _w((lambda *s: torch.randn(*s, dtype=torch.bfloat16) * 1.6)(Hq * Dh, D) * ((Hq * Dh) ** -0.5)),
        }
    _A_in = _A_setup()

    def _B_setup():
        B, S, D, F = 1, 1, 512, 1792
        return {
            "x": _w((lambda *s: torch.randn(*s, dtype=torch.bfloat16) * 0.4)(B, S, D)),
            "w1": _w((lambda *s: torch.randn(*s, dtype=torch.bfloat16) * 1.6)(D, F) * (D ** -0.5)),
            "b1": _w((lambda *s: torch.randn(*s, dtype=torch.bfloat16) * 1.6)(F) * 0.01),
            "w2": _w((lambda *s: torch.randn(*s, dtype=torch.bfloat16) * 1.6)(F, D) * (F ** -0.5)),
            "b2": _w((lambda *s: torch.randn(*s, dtype=torch.bfloat16) * 1.6)(D) * 0.01),
        }
    _B_in = _B_setup()

    return {
        "A_x": _A_in["x"],
        "A_k_cache": _A_in["k_cache"],
        "A_v_cache": _A_in["v_cache"],
        "A_wq": _A_in["wq"],
        "A_wo": _A_in["wo"],
        "B_x": _B_in["x"],
        "B_w1": _B_in["w1"],
        "B_b1": _B_in["b1"],
        "B_w2": _B_in["w2"],
        "B_b2": _B_in["b2"],
    }

def reference(A_x, A_k_cache, A_v_cache, A_wq, A_wo, B_x, B_w1, B_b1, B_w2, B_b2):
    def _A_ref(x, k_cache, v_cache, wq, wo):
        B, Sq, D = x.shape
        Hq, Dh = 32, 128
        Hkv, Sk = k_cache.shape[1], k_cache.shape[2]
        W = min(4096, max(256, Sk // 4))
        rep = Hq // Hkv
        q = (lambda x, *d: x.permute(*d))((x @ wq).reshape(B, Sq, Hq, Dh), 0, 2, 1, 3)
        k = (lambda x, n, axis: torch.repeat_interleave(x, n, dim=axis))(k_cache[:, :, Sk - W:, :], rep, axis=1)
        v = (lambda x, n, axis: torch.repeat_interleave(x, n, dim=axis))(v_cache[:, :, Sk - W:, :], rep, axis=1)
        scores = torch.einsum("bhqd,bhkd->bhqk", q, k) * (Dh ** -0.5)
        p = _softmax(scores, axis=-1)
        o = torch.einsum("bhqk,bhkd->bhqd", p, v)
        return (lambda x, *d: x.permute(*d))(o, 0, 2, 1, 3).reshape(B, Sq, Hq * Dh) @ wo

    def _B_ref(x, w1, b1, w2, b2):
        h = torch.einsum("bsd,df->bsf", x, w1) + b1
        h = _gelu(h)
        return torch.einsum("bsf,fd->bsd", h, w2) + b2

    x = A_x
    xn = _layernorm(x, axis=-1)
    s = _A_ref(xn, A_k_cache, A_v_cache, A_wq, A_wo)
    g = _silu(_B_ref(xn, B_w1, B_b1, B_w2, B_b2))
    return x + s * g
```

```asm
; @launch grid=(256,1,1) block=(576,1,1) lds=13056
.amdgcn_target "amdgcn-amd-amdhsa--gfx950"
.text
.globl recurrent_scan__sliding_block_cached__dense_activation_gelu__decode_kernel
.p2align 10
.p2align 8
.type recurrent_scan__sliding_block_cached__dense_activation_gelu__decode_kernel,@function
recurrent_scan__sliding_block_cached__dense_activation_gelu__decode_kernel:
L_start:
    s_load_dwordx16 s[16:31], s[0:1], 0
    s_load_dwordx8 s[32:39], s[0:1], 64
    s_load_dwordx2 s[40:41], s[0:1], 96
    v_lshrrev_b32 v1, 6, v0
    v_and_b32 v0, 63, v0
    s_cmpk_ge_u32 s2, 0x100
    s_cbranch_scc1 L_end
    v_readfirstlane_b32 s3, v1
    s_and_b32 s4, s2, 7
    s_lshr_b32 s5, s2, 4
    v_lshrrev_b32 v2, 4, v0
    v_and_b32 v3, 15, v0
    s_mov_b32 s47, 0x20000
    s_bitcmp1_b32 s2, 3
    s_cbranch_scc0 T_A
    s_cmp_ge_u32 s3, 2
    s_cbranch_scc1 T_W2
    v_lshrrev_b32 v6, 3, v0
    v_and_b32 v7, 7, v0
    v_lshlrev_b32 v5, 17, v6
    v_lshl_add_u32 v5, v7, 4, v5
    v_lshlrev_b32 v4, 4, v0
    s_lshr_b32 s56, s5, 2
    s_and_b32 s13, s5, 3
    s_lshl2_add_u32 s13, s3, s13
    s_cmp_eq_u32 s13, 7
    s_cbranch_scc1 R_Q7
    s_lshl_b32 s14, s56, 20
    s_lshl3_add_u32 s15, s4, s13
    s_lshl_b32 s15, s15, 7
    s_add_u32 s14, s14, s15
    s_movk_i32 s15, 0x2000
    s_mov_b32 s46, 0x400000
    s_waitcnt lgkmcnt(0)
    s_mov_b64 s[44:45], s[22:23]
    global_load_dwordx4 v[16:19], v4, s[16:17]

L_load16:
    buffer_load_dwordx4 v[64:67], v5, s[44:47], s14 offen nt
    s_add_u32 s14, s14, s15
    buffer_load_dwordx4 v[68:71], v5, s[44:47], s14 offen nt
    s_add_u32 s14, s14, s15
    buffer_load_dwordx4 v[72:75], v5, s[44:47], s14 offen nt
    s_add_u32 s14, s14, s15
    buffer_load_dwordx4 v[76:79], v5, s[44:47], s14 offen nt
    s_add_u32 s14, s14, s15
    buffer_load_dwordx4 v[80:83], v5, s[44:47], s14 offen nt
    s_add_u32 s14, s14, s15
    buffer_load_dwordx4 v[84:87], v5, s[44:47], s14 offen nt
    s_add_u32 s14, s14, s15
    buffer_load_dwordx4 v[88:91], v5, s[44:47], s14 offen nt
    s_add_u32 s14, s14, s15
    buffer_load_dwordx4 v[92:95], v5, s[44:47], s14 offen nt
    s_add_u32 s14, s14, s15
    buffer_load_dwordx4 v[96:99], v5, s[44:47], s14 offen nt
    s_add_u32 s14, s14, s15
    buffer_load_dwordx4 v[100:103], v5, s[44:47], s14 offen nt
    s_add_u32 s14, s14, s15
    buffer_load_dwordx4 v[104:107], v5, s[44:47], s14 offen nt
    s_add_u32 s14, s14, s15
    buffer_load_dwordx4 v[108:111], v5, s[44:47], s14 offen nt
    s_add_u32 s14, s14, s15
    buffer_load_dwordx4 v[112:115], v5, s[44:47], s14 offen nt
    s_add_u32 s14, s14, s15
    buffer_load_dwordx4 v[116:119], v5, s[44:47], s14 offen nt
    s_add_u32 s14, s14, s15
    buffer_load_dwordx4 v[120:123], v5, s[44:47], s14 offen nt
    s_add_u32 s14, s14, s15
    buffer_load_dwordx4 v[124:127], v5, s[44:47], s14 offen nt
    s_branch R_Q
R_P:
    s_getpc_b64 s[12:13]
L_pc:
    s_and_b32 s14, s5, 1
    s_lshl_b32 s14, s14, 13
    v_lshl_add_u32 v4, v0, 7, s14
    v_min_u32 v4, L_codeend-L_pc-4, v4
    global_load_dword v62, v4, s[12:13]
    s_setprio 3
    v_lshlrev_b32 v8, 2, v0
    v_mov_b32 v9, 0
    v_mov_b32 v4, 0xff800000
    v_lshrrev_b32 v5, 2, v0
    v_cmp_eq_u32 vcc, 12, v5
    v_and_b32 v6, 3, v0
    v_lshlrev_b32 v7, 16, v5
    v_cndmask_b32 v9, v9, v4, vcc
    ds_write_b32 v8, v9 offset:12288
    v_lshl_add_u32 v7, v6, 7, v7
    s_lshl4_add_u32 s57, s4, s5
    s_lshl_b32 s57, s57, 9
    s_add_u32 s10, s57, 0x10000
    s_mov_b32 s42, 0x10000000
    s_mov_b32 s43, 0x20000
    v_lshrrev_b32 v6, 3, v0
    v_and_b32 v12, 7, v0
    v_lshlrev_b32 v5, 15, v6
    v_lshl_add_u32 v5, v12, 4, v5
    v_lshlrev_b32 v4, 4, v0
    s_lshl_b32 s14, s5, 18
    s_lshl_b32 s15, s4, 10
    s_add_u32 s14, s14, s15
    s_movk_i32 s15, 0x2000
    s_mov_b32 s46, 0x400000
    s_waitcnt lgkmcnt(0)
    s_mov_b64 s[44:45], s[22:23]
    global_load_dwordx4 v[16:19], v4, s[16:17]
    buffer_load_dwordx4 v[64:67], v5, s[44:47], s14 offen offset:896 nt
    s_add_u32 s14, s14, s15
    buffer_load_dwordx4 v[68:71], v5, s[44:47], s14 offen offset:896 nt
    s_add_u32 s14, s14, s15
    buffer_load_dwordx4 v[72:75], v5, s[44:47], s14 offen offset:896 nt
    s_add_u32 s14, s14, s15
    buffer_load_dwordx4 v[76:79], v5, s[44:47], s14 offen offset:896 nt
    s_mov_b32 exec_hi, 15
    buffer_load_dword v63, v7, s[40:43], s10 offen sc1
    s_mov_b64 exec, -1
    s_load_dword s6, s[40:41], 0

    s_barrier
    s_branch R_P2
T_W2:
    s_cmp_lt_u32 s3, 8
    s_cbranch_scc1 T_W3
    v_lshlrev_b32 v8, 2, v0
    v_mov_b32 v9, 0
    ds_write_b32 v8, v9 offset:12288
    s_waitcnt lgkmcnt(0)
    s_barrier
    s_endpgm
T_W3:
    s_barrier
    s_cmp_ge_u32 s3, 4
    s_cbranch_scc1 R_WO
    s_branch R_B
T_V:
    s_barrier
    s_branch R_V
T_A:
    s_cmp_ge_u32 s3, 5
    s_cbranch_scc1 T_V
    s_cmp_eq_u32 s3, 0
    s_cbranch_scc1 R_P
    v_lshlrev_b32 v5, 6, v3
    v_lshl_add_u32 v5, v2, 4, v5
    s_sub_u32 s56, s3, 1
    s_lshl2_add_u32 s13, s5, s56
    s_lshl_b32 s13, s13, 10
    s_lshl_b32 s14, s4, 23
    s_add_u32 s14, s14, s13
    s_add_u32 s14, s14, 7340032
    s_mov_b32 s15, 0x10000
    s_mov_b32 s46, 0x4000000
    s_waitcnt lgkmcnt(0)
    s_mov_b64 s[44:45], s[18:19]
    s_barrier

    buffer_load_dwordx4 v[64:67], v5, s[44:47], s14 offen nt
    s_xor_b32 s13, s14, 0x11000
    buffer_load_dwordx4 v[68:71], v5, s[44:47], s13 offen nt
    s_xor_b32 s13, s14, 0x22000
    buffer_load_dwordx4 v[72:75], v5, s[44:47], s13 offen nt
    s_xor_b32 s13, s14, 0x33000
    buffer_load_dwordx4 v[76:79], v5, s[44:47], s13 offen nt
    s_xor_b32 s13, s14, 0x44400
    buffer_load_dwordx4 v[80:83], v5, s[44:47], s13 offen nt
    v_mov_b32 v8, 12464
    s_mov_b32 s9, 0
SPIN_1:
    ds_read_b32 v9, v8
    s_add_u32 s9, s9, 1
    s_cmp_gt_u32 s9, 200000
    s_cbranch_scc1 SPINX_2
    s_waitcnt lgkmcnt(0)
    v_readfirstlane_b32 s10, v9
    s_cmp_ge_u32 s10, 1
    s_cbranch_scc1 SPINX_2
    s_sleep 1
    s_branch SPIN_1
SPINX_2:
    s_waitcnt lgkmcnt(0)
    s_xor_b32 s13, s14, 0x55400
    buffer_load_dwordx4 v[84:87], v5, s[44:47], s13 offen nt
    s_xor_b32 s13, s14, 0x66400
    buffer_load_dwordx4 v[88:91], v5, s[44:47], s13 offen nt
    s_xor_b32 s13, s14, 0x77400
    buffer_load_dwordx4 v[92:95], v5, s[44:47], s13 offen nt
    s_xor_b32 s13, s14, 0x88800
    buffer_load_dwordx4 v[96:99], v5, s[44:47], s13 offen nt
    s_xor_b32 s13, s14, 0x99800
    buffer_load_dwordx4 v[100:103], v5, s[44:47], s13 offen nt
    s_xor_b32 s13, s14, 0xaa800
    buffer_load_dwordx4 v[104:107], v5, s[44:47], s13 offen nt
    s_xor_b32 s13, s14, 0xbb800
    buffer_load_dwordx4 v[108:111], v5, s[44:47], s13 offen nt
    s_xor_b32 s13, s14, 0xccc00
    buffer_load_dwordx4 v[112:115], v5, s[44:47], s13 offen nt
    s_xor_b32 s13, s14, 0xddc00
    buffer_load_dwordx4 v[116:119], v5, s[44:47], s13 offen nt
    s_xor_b32 s13, s14, 0xeec00
    buffer_load_dwordx4 v[120:123], v5, s[44:47], s13 offen nt
    s_xor_b32 s13, s14, 0xffc00
    buffer_load_dwordx4 v[124:127], v5, s[44:47], s13 offen nt
    s_branch R_K
L_kb_end:
R_Q:
    s_barrier
    s_load_dword s6, s[40:41], 0
    s_mov_b32 s42, 0x10000000
    s_mov_b32 s43, 0x20000
    s_mov_b32 s60, 0x05040100
    s_mov_b32 s61, 0x07060302
    v_mov_b32 v15, 0xfffff000

    s_lshl_b32 s57, s3, 10
    v_add_u32 v8, s57, v4
    v_and_b32 v56, 1, v0
    v_cmp_eq_u32 vcc, 1, v56
    v_mov_b32 v56, 0x0c0c0100
    v_mov_b32 v57, 0x01000c0c
    v_cndmask_b32 v57, v56, v57, vcc
    v_mov_b32 v56, 0x0c0c0302
    v_mov_b32 v58, 0x03020c0c
    v_cndmask_b32 v58, v56, v58, vcc
    v_bfe_u32 v56, v0, 1, 2
    v_mov_b32 v59, 0x0c0c0c0c
    v_cmp_eq_u32 vcc, 0, v56
    s_nop 1
    v_cndmask_b32 v36, v59, v57, vcc
    v_cndmask_b32 v37, v59, v58, vcc
    v_cmp_eq_u32 vcc, 1, v56
    s_nop 1
    v_cndmask_b32 v38, v59, v57, vcc
    v_cndmask_b32 v39, v59, v58, vcc
    v_cmp_eq_u32 vcc, 2, v56
    s_nop 1
    v_cndmask_b32 v40, v59, v57, vcc
    v_cndmask_b32 v41, v59, v58, vcc
    v_cmp_eq_u32 vcc, 3, v56
    s_nop 1
    v_cndmask_b32 v42, v59, v57, vcc
    v_cndmask_b32 v43, v59, v58, vcc
    s_waitcnt vmcnt(16)
    v_lshlrev_b32 v20, 16, v16
    v_and_b32 v21, 0xffff0000, v16
    v_lshlrev_b32 v22, 16, v17
    v_and_b32 v23, 0xffff0000, v17
    v_lshlrev_b32 v24, 16, v18
    v_and_b32 v25, 0xffff0000, v18
    v_lshlrev_b32 v26, 16, v19
    v_and_b32 v27, 0xffff0000, v19
    v_readlane_b32 s11, v20, 0
    s_nop 1
    v_subrev_f32 v56, s11, v20
    v_mul_f32 v57, v56, v56
    v_subrev_f32 v58, s11, v21
    v_add_f32 v56, v56, v58
    v_fmac_f32 v57, v58, v58
    v_subrev_f32 v58, s11, v22
    v_add_f32 v56, v56, v58
    v_fmac_f32 v57, v58, v58
    v_subrev_f32 v58, s11, v23
    v_add_f32 v56, v56, v58
    v_fmac_f32 v57, v58, v58
    v_subrev_f32 v58, s11, v24
    v_add_f32 v56, v56, v58
    v_fmac_f32 v57, v58, v58
    v_subrev_f32 v58, s11, v25
    v_add_f32 v56, v56, v58
    v_fmac_f32 v57, v58, v58
    v_subrev_f32 v58, s11, v26
    v_add_f32 v56, v56, v58
    v_fmac_f32 v57, v58, v58
    v_subrev_f32 v58, s11, v27
    v_add_f32 v56, v56, v58
    v_fmac_f32 v57, v58, v58
    s_nop 0
    v_add_f32_dpp v56, v56, v56 row_ror:1 row_mask:0xf bank_mask:0xf
    v_add_f32_dpp v57, v57, v57 row_ror:1 row_mask:0xf bank_mask:0xf
    s_nop 0
    v_add_f32_dpp v56, v56, v56 row_ror:2 row_mask:0xf bank_mask:0xf
    v_add_f32_dpp v57, v57, v57 row_ror:2 row_mask:0xf bank_mask:0xf
    s_nop 0
    v_add_f32_dpp v56, v56, v56 row_ror:4 row_mask:0xf bank_mask:0xf
    v_add_f32_dpp v57, v57, v57 row_ror:4 row_mask:0xf bank_mask:0xf
    s_nop 0
    v_add_f32_dpp v56, v56, v56 row_ror:8 row_mask:0xf bank_mask:0xf
    v_add_f32_dpp v57, v57, v57 row_ror:8 row_mask:0xf bank_mask:0xf
    s_nop 0
    v_add_f32_dpp v56, v56, v56 row_bcast:15 row_mask:0xa bank_mask:0xf
    v_add_f32_dpp v57, v57, v57 row_bcast:15 row_mask:0xa bank_mask:0xf
    s_nop 0
    v_add_f32_dpp v56, v56, v56 row_bcast:31 row_mask:0xc bank_mask:0xf
    v_add_f32_dpp v57, v57, v57 row_bcast:31 row_mask:0xc bank_mask:0xf
    v_readlane_b32 s58, v56, 63
    v_readlane_b32 s59, v57, 63
    v_mov_b32 v58, 0x3b000000
    v_mul_f32 v56, s58, v58
    v_mul_f32 v57, s59, v58
    v_fma_f32 v57, -v56, v56, v57
    v_add_f32 v56, s11, v56
    v_max_f32 v57, 0, v57
    v_cvt_pk_bf16_f32 v57, v56, v57
    v_lshlrev_b32 v56, 16, v57
    v_and_b32 v57, 0xffff0000, v57
    v_add_f32 v57, 0x3727c5ac, v57
    v_sub_f32 v20, v20, v56
    v_sub_f32 v21, v21, v56
    v_sub_f32 v22, v22, v56
    v_sub_f32 v23, v23, v56
    v_cvt_pk_bf16_f32 v57, v57, v57
    v_lshlrev_b32 v57, 16, v57
    v_sub_f32 v24, v24, v56
    v_sub_f32 v25, v25, v56
    v_sub_f32 v26, v26, v56
    v_sub_f32 v27, v27, v56
    v_sqrt_f32 v57, v57
    v_cvt_pk_bf16_f32 v16, v20, v21
    v_cvt_pk_bf16_f32 v17, v22, v23
    v_cvt_pk_bf16_f32 v18, v24, v25
    v_cvt_pk_bf16_f32 v19, v26, v27
    v_cvt_pk_bf16_f32 v57, v57, v57
    v_lshlrev_b32 v57, 16, v57
    v_rcp_f32 v57, v57
    v_lshlrev_b32 v20, 16, v16
    v_and_b32 v21, 0xffff0000, v16
    v_lshlrev_b32 v22, 16, v17
    v_and_b32 v23, 0xffff0000, v17
    v_lshlrev_b32 v24, 16, v18
    v_and_b32 v25, 0xffff0000, v18
    v_lshlrev_b32 v26, 16, v19
    v_and_b32 v27, 0xffff0000, v19
    v_mul_f32 v20, v20, v57
    v_mul_f32 v21, v21, v57
    v_mul_f32 v22, v22, v57
    v_mul_f32 v23, v23, v57
    v_mul_f32 v24, v24, v57
    v_mul_f32 v25, v25, v57
    v_mul_f32 v26, v26, v57
    v_mul_f32 v27, v27, v57
    v_cvt_pk_bf16_f32 v16, v20, v21
    v_cvt_pk_bf16_f32 v17, v22, v23
    v_cvt_pk_bf16_f32 v18, v24, v25
    v_cvt_pk_bf16_f32 v19, v26, v27
    ds_write_b128 v8, v[16:19]
    s_lshl_b32 s15, s56, 8
    s_add_u32 s15, s15, s57
    v_lshl_add_u32 v8, v6, 5, s15
    ds_read_b128 v[28:31], v8
    ds_read_b128 v[32:35], v8 offset:16
    v_lshlrev_b32 v6, 4, v2
    v_lshl_add_u32 v6, v7, 5, v6
    s_lshl3_add_u32 s63, s56, s13
    s_lshl_b32 s14, s4, 5
    s_add_u32 s14, s14, s63
    s_lshl_b32 s14, s14, 8
    s_add_u32 s14, s14, 0x10000
    s_add_u32 s62, s14, 0x90000

    s_waitcnt lgkmcnt(0)
    s_add_u32 s8, s6, 1
    s_and_b32 s7, s8, 0xfff
    s_and_b32 s94, s8, 0x3ff
    s_and_b32 s90, s8, 0xff
    s_mul_i32 s90, s90, 0x01010101
    s_mov_b32 s91, s90
    s_lshl_b32 s92, s4, 13
    s_add_u32 s92, s92, 0x30000
    v_lshlrev_b32 v12, 9, v0
    v_mov_b32 v13, s90
    v_mov_b32 v8, 12440
    s_mov_b32 s9, 0
SPIN_3:
    ds_read_b32 v9, v8
    s_add_u32 s9, s9, 1
    s_cmp_gt_u32 s9, 200000
    s_cbranch_scc1 SPINX_4
    s_waitcnt lgkmcnt(0)
    v_readfirstlane_b32 s10, v9
    s_cmp_ge_u32 s10, 6
    s_cbranch_scc1 SPINX_4
    s_branch SPIN_3
SPINX_4:
    s_waitcnt lgkmcnt(0)
    v_perm_b32 v44, v28, v28, v36
    v_perm_b32 v45, v28, v28, v38
    v_perm_b32 v46, v28, v28, v40
    v_perm_b32 v47, v28, v28, v42
    v_perm_b32 v48, v28, v28, v37
    v_perm_b32 v49, v28, v28, v39
    v_perm_b32 v50, v28, v28, v41
    v_perm_b32 v51, v28, v28, v43
    s_waitcnt vmcnt(15)
    v_mfma_f32_16x16x32_bf16 v[52:55], v[44:47], v[64:67], 0
    v_perm_b32 v44, v29, v29, v36
    v_perm_b32 v45, v29, v29, v38
    v_perm_b32 v46, v29, v29, v40
    v_perm_b32 v47, v29, v29, v42
    s_waitcnt vmcnt(14)
    v_mfma_f32_16x16x32_bf16 v[52:55], v[48:51], v[68:71], v[52:55]
    v_perm_b32 v48, v29, v29, v37
    v_perm_b32 v49, v29, v29, v39
    v_perm_b32 v50, v29, v29, v41
    v_perm_b32 v51, v29, v29, v43
    s_waitcnt vmcnt(13)
    v_mfma_f32_16x16x32_bf16 v[52:55], v[44:47], v[72:75], v[52:55]
    v_perm_b32 v44, v30, v30, v36
    v_perm_b32 v45, v30, v30, v38
    v_perm_b32 v46, v30, v30, v40
    v_perm_b32 v47, v30, v30, v42
    s_waitcnt vmcnt(12)
    v_mfma_f32_16x16x32_bf16 v[52:55], v[48:51], v[76:79], v[52:55]
    v_perm_b32 v48, v30, v30, v37
    v_perm_b32 v49, v30, v30, v39
    v_perm_b32 v50, v30, v30, v41
    v_perm_b32 v51, v30, v30, v43
    s_waitcnt vmcnt(11)
    v_mfma_f32_16x16x32_bf16 v[52:55], v[44:47], v[80:83], v[52:55]
    v_perm_b32 v44, v31, v31, v36
    v_perm_b32 v45, v31, v31, v38
    v_perm_b32 v46, v31, v31, v40
    v_perm_b32 v47, v31, v31, v42
    s_waitcnt vmcnt(10)
    v_mfma_f32_16x16x32_bf16 v[52:55], v[48:51], v[84:87], v[52:55]
    v_perm_b32 v48, v31, v31, v37
    v_perm_b32 v49, v31, v31, v39
    v_perm_b32 v50, v31, v31, v41
    v_perm_b32 v51, v31, v31, v43
    s_waitcnt vmcnt(9)
    v_mfma_f32_16x16x32_bf16 v[52:55], v[44:47], v[88:91], v[52:55]
    v_perm_b32 v44, v32, v32, v36
    v_perm_b32 v45, v32, v32, v38
    v_perm_b32 v46, v32, v32, v40
    v_perm_b32 v47, v32, v32, v42
    s_waitcnt vmcnt(8)
    v_mfma_f32_16x16x32_bf16 v[52:55], v[48:51], v[92:95], v[52:55]
    v_perm_b32 v48, v32, v32, v37
    v_perm_b32 v49, v32, v32, v39
    v_perm_b32 v50, v32, v32, v41
    v_perm_b32 v51, v32, v32, v43
    s_waitcnt vmcnt(7)
    v_mfma_f32_16x16x32_bf16 v[52:55], v[44:47], v[96:99], v[52:55]
    v_perm_b32 v44, v33, v33, v36
    v_perm_b32 v45, v33, v33, v38
    v_perm_b32 v46, v33, v33, v40
    v_perm_b32 v47, v33, v33, v42
    s_waitcnt vmcnt(6)
    v_mfma_f32_16x16x32_bf16 v[52:55], v[48:51], v[100:103], v[52:55]
    v_perm_b32 v48, v33, v33, v37
    v_perm_b32 v49, v33, v33, v39
    v_perm_b32 v50, v33, v33, v41
    v_perm_b32 v51, v33, v33, v43
    s_waitcnt vmcnt(5)
    v_mfma_f32_16x16x32_bf16 v[52:55], v[44:47], v[104:107], v[52:55]
    v_perm_b32 v44, v34, v34, v36
    v_perm_b32 v45, v34, v34, v38
    v_perm_b32 v46, v34, v34, v40
    v_perm_b32 v47, v34, v34, v42
    s_waitcnt vmcnt(4)
    v_mfma_f32_16x16x32_bf16 v[52:55], v[48:51], v[108:111], v[52:55]
    v_perm_b32 v48, v34, v34, v37
    v_perm_b32 v49, v34, v34, v39
    v_perm_b32 v50, v34, v34, v41
    v_perm_b32 v51, v34, v34, v43
    s_waitcnt vmcnt(3)
    v_mfma_f32_16x16x32_bf16 v[52:55], v[44:47], v[112:115], v[52:55]
    v_perm_b32 v44, v35, v35, v36
    v_perm_b32 v45, v35, v35, v38
    v_perm_b32 v46, v35, v35, v40
    v_perm_b32 v47, v35, v35, v42
    s_waitcnt vmcnt(2)
    v_mfma_f32_16x16x32_bf16 v[52:55], v[48:51], v[116:119], v[52:55]
    v_perm_b32 v48, v35, v35, v37
    v_perm_b32 v49, v35, v35, v39
    v_perm_b32 v50, v35, v35, v41
    v_perm_b32 v51, v35, v35, v43
    s_waitcnt vmcnt(1)
    v_mfma_f32_16x16x32_bf16 v[52:55], v[44:47], v[120:123], v[52:55]
    s_waitcnt vmcnt(0)
    v_mfma_f32_16x16x32_bf16 v[52:55], v[48:51], v[124:127], v[52:55]
    s_nop 7
    v_mov_b32 v56, v52
    v_mov_b32 v57, v53
    v_mov_b32 v58, v54
    v_mov_b32 v59, v55
    v_permlane32_swap_b32 v52, v56
    v_permlane32_swap_b32 v53, v57
    v_permlane32_swap_b32 v54, v58
    v_permlane32_swap_b32 v55, v59
    v_add_f32_dpp v52, v56, v52 row_ror:8 row_mask:0xf bank_mask:0xf
    v_add_f32_dpp v53, v57, v53 row_ror:8 row_mask:0xf bank_mask:0xf
    v_add_f32_dpp v54, v58, v54 row_ror:8 row_mask:0xf bank_mask:0xf
    v_add_f32_dpp v55, v59, v55 row_ror:8 row_mask:0xf bank_mask:0xf
    v_mov_b32 v56, 0xfffffc00
    v_add_u32 v52, 0x200, v52
    v_add_u32 v53, 0x200, v53
    v_add_u32 v54, 0x200, v54
    v_add_u32 v55, 0x200, v55
    v_and_or_b32 v52, v52, v56, s94
    v_and_or_b32 v53, v53, v56, s94
    v_and_or_b32 v54, v54, v56, s94
    v_and_or_b32 v55, v55, v56, s94
    s_mov_b64 exec, 0x00ff00ff
    buffer_store_dwordx4 v[52:55], v6, s[40:43], s14 offen
    s_add_u32 s15, s92, s63
    s_mov_b64 exec, 0xffff
    buffer_store_byte v13, v12, s[40:43], s15 offen
    s_mov_b64 exec, -1
    s_mov_b64 exec, 0x00ff00ff
    buffer_store_dwordx4 v[52:55], v6, s[40:43], s62 offen sc1
    s_mov_b64 exec, -1
    v_mov_b32 v8, 12444
    v_mov_b32 v9, 1
    s_mov_b64 exec, 1
    ds_add_u32 v8, v9
    s_mov_b64 exec, -1
Q_vpf:
    v_mov_b32 v8, 12464
    s_mov_b32 s9, 0
SPIN_5:
    ds_read_b32 v9, v8
    s_add_u32 s9, s9, 1
    s_cmp_gt_u32 s9, 200000
    s_cbranch_scc1 SPINX_6
    s_waitcnt lgkmcnt(0)
    v_readfirstlane_b32 s10, v9
    s_cmp_ge_u32 s10, 2
    s_cbranch_scc1 SPINX_6
    s_branch SPIN_5
SPINX_6:
    s_waitcnt lgkmcnt(0)
    s_mov_b64 s[44:45], s[20:21]
    s_mov_b32 s46, 0x4000000
    s_lshl_b32 s13, s3, 1
    s_lshl2_add_u32 s13, s5, s13
    s_lshl_b32 s13, s13, 10
    s_lshl_b32 s12, s4, 23
    s_add_u32 s12, s12, s13
    s_add_u32 s12, s12, 7340032

    s_xor_b32 s13, s12, 0x88800
    buffer_load_dwordx4 v[64:67], v4, s[44:47], s13 offen sc1
    s_xor_b32 s13, s12, 0x88c00
    buffer_load_dwordx4 v[68:71], v4, s[44:47], s13 offen sc1
    s_xor_b32 s13, s12, 0x99800
    buffer_load_dwordx4 v[72:75], v4, s[44:47], s13 offen sc1
    s_xor_b32 s13, s12, 0x99c00
    buffer_load_dwordx4 v[76:79], v4, s[44:47], s13 offen sc1
    s_xor_b32 s13, s12, 0xaa800
    buffer_load_dwordx4 v[80:83], v4, s[44:47], s13 offen sc1
    s_xor_b32 s13, s12, 0xaac00
    buffer_load_dwordx4 v[84:87], v4, s[44:47], s13 offen sc1
    s_xor_b32 s13, s12, 0xbb800
    buffer_load_dwordx4 v[88:91], v4, s[44:47], s13 offen sc1
    s_xor_b32 s13, s12, 0xbbc00
    buffer_load_dwordx4 v[92:95], v4, s[44:47], s13 offen sc1
    s_xor_b32 s13, s12, 0xccc00
    buffer_load_dwordx4 v[96:99], v4, s[44:47], s13 offen sc1
    s_xor_b32 s13, s12, 0xcc800
    buffer_load_dwordx4 v[100:103], v4, s[44:47], s13 offen sc1
    s_xor_b32 s13, s12, 0xddc00
    buffer_load_dwordx4 v[104:107], v4, s[44:47], s13 offen sc1
    s_xor_b32 s13, s12, 0xdd800
    buffer_load_dwordx4 v[108:111], v4, s[44:47], s13 offen sc1
    s_xor_b32 s13, s12, 0xeec00
    buffer_load_dwordx4 v[112:115], v4, s[44:47], s13 offen sc1
    s_xor_b32 s13, s12, 0xee800
    buffer_load_dwordx4 v[116:119], v4, s[44:47], s13 offen sc1
    s_xor_b32 s13, s12, 0xffc00
    buffer_load_dwordx4 v[120:123], v4, s[44:47], s13 offen sc1
    s_xor_b32 s13, s12, 0xff800
    buffer_load_dwordx4 v[124:127], v4, s[44:47], s13 offen sc1
    v_mov_b32 v8, 12444
    v_mov_b32 v9, 32
    s_mov_b64 exec, 1
    ds_add_u32 v8, v9
    s_mov_b64 exec, -1

    s_endpgm
R_Q7:
    s_waitcnt lgkmcnt(0)
    s_barrier
    s_load_dword s6, s[40:41], 0
    s_mov_b32 s42, 0x10000000
    s_mov_b32 s43, 0x20000
    s_mov_b32 s60, 0x05040100
    s_mov_b32 s61, 0x07060302
    v_mov_b32 v15, 0xfffff000

    s_lshl3_add_u32 s63, s56, s13
    s_waitcnt lgkmcnt(0)
    s_add_u32 s8, s6, 1
    s_and_b32 s7, s8, 0xfff
    s_and_b32 s94, s8, 0x3ff
    s_and_b32 s90, s8, 0xff
    s_mul_i32 s90, s90, 0x01010101
    s_mov_b32 s91, s90
    s_lshl_b32 s92, s4, 13
    s_add_u32 s92, s92, 0x30000
    v_lshlrev_b32 v12, 9, v0
    v_mov_b32 v13, s90
    v_mov_b32 v8, 12444
    s_mov_b32 s9, 0
SPIN_7:
    ds_read_b32 v9, v8
    s_add_u32 s9, s9, 1
    s_cmp_gt_u32 s9, 200000
    s_cbranch_scc1 SPINX_8
    s_waitcnt lgkmcnt(0)
    v_readfirstlane_b32 s10, v9
    s_cmp_ge_u32 s10, 1
    s_cbranch_scc1 SPINX_8
    s_sleep 2
    s_branch SPIN_7
SPINX_8:
    s_waitcnt lgkmcnt(0)
    s_add_u32 s15, s92, s63
    s_mov_b64 exec, 0xffff
    buffer_store_byte v13, v12, s[40:43], s15 offen
    s_mov_b64 exec, -1
    v_mov_b32 v8, 12444
    v_mov_b32 v9, 1
    s_mov_b64 exec, 1
    ds_add_u32 v8, v9
    s_mov_b64 exec, -1
    s_branch Q_vpf
    s_endpgm
R_P2:
    s_mov_b32 s44, s16
    s_mov_b32 s45, s17
    s_mov_b32 s46, 0x400
    s_mov_b32 s47, 0x20000
    s_mov_b32 s48, s34
    s_mov_b32 s49, s35
    s_mov_b32 s50, 0x400
    s_mov_b32 s51, 0x20000
    s_mov_b32 s52, s36
    s_mov_b32 s53, s37
    s_mov_b32 s54, 0x400
    s_mov_b32 s55, 0x20000
    s_mov_b32 s42, 0x10000000
    s_mov_b32 s43, 0x20000
    s_mov_b32 s60, 0x05040100
    s_mov_b32 s61, 0x07060302
    v_mov_b32 v15, 0xfffff000

    v_and_b32 v56, 1, v0
    v_cmp_eq_u32 vcc, 1, v56
    v_mov_b32 v56, 0x0c0c0100
    v_mov_b32 v57, 0x01000c0c
    v_cndmask_b32 v57, v56, v57, vcc
    v_mov_b32 v56, 0x0c0c0302
    v_mov_b32 v58, 0x03020c0c
    v_cndmask_b32 v58, v56, v58, vcc
    v_bfe_u32 v56, v0, 1, 2
    v_mov_b32 v59, 0x0c0c0c0c
    v_cmp_eq_u32 vcc, 0, v56
    s_nop 1
    v_cndmask_b32 v36, v59, v57, vcc
    v_cndmask_b32 v37, v59, v58, vcc
    v_cmp_eq_u32 vcc, 1, v56
    s_nop 1
    v_cndmask_b32 v38, v59, v57, vcc
    v_cndmask_b32 v39, v59, v58, vcc
    v_cmp_eq_u32 vcc, 2, v56
    s_nop 1
    v_cndmask_b32 v40, v59, v57, vcc
    v_cndmask_b32 v41, v59, v58, vcc
    v_cmp_eq_u32 vcc, 3, v56
    s_nop 1
    v_cndmask_b32 v42, v59, v57, vcc
    v_cndmask_b32 v43, v59, v58, vcc
    v_add_u32 v8, 4096, v4
    s_waitcnt vmcnt(5)
    v_lshlrev_b32 v20, 16, v16
    v_and_b32 v21, 0xffff0000, v16
    v_lshlrev_b32 v22, 16, v17
    v_and_b32 v23, 0xffff0000, v17
    v_lshlrev_b32 v24, 16, v18
    v_and_b32 v25, 0xffff0000, v18
    v_lshlrev_b32 v26, 16, v19
    v_and_b32 v27, 0xffff0000, v19
    v_readlane_b32 s11, v20, 0
    s_nop 1
    v_subrev_f32 v56, s11, v20
    v_mul_f32 v57, v56, v56
    v_subrev_f32 v58, s11, v21
    v_add_f32 v56, v56, v58
    v_fmac_f32 v57, v58, v58
    v_subrev_f32 v58, s11, v22
    v_add_f32 v56, v56, v58
    v_fmac_f32 v57, v58, v58
    v_subrev_f32 v58, s11, v23
    v_add_f32 v56, v56, v58
    v_fmac_f32 v57, v58, v58
    v_subrev_f32 v58, s11, v24
    v_add_f32 v56, v56, v58
    v_fmac_f32 v57, v58, v58
    v_subrev_f32 v58, s11, v25
    v_add_f32 v56, v56, v58
    v_fmac_f32 v57, v58, v58
    v_subrev_f32 v58, s11, v26
    v_add_f32 v56, v56, v58
    v_fmac_f32 v57, v58, v58
    v_subrev_f32 v58, s11, v27
    v_add_f32 v56, v56, v58
    v_fmac_f32 v57, v58, v58
    s_nop 0
    v_add_f32_dpp v56, v56, v56 row_ror:1 row_mask:0xf bank_mask:0xf
    v_add_f32_dpp v57, v57, v57 row_ror:1 row_mask:0xf bank_mask:0xf
    s_nop 0
    v_add_f32_dpp v56, v56, v56 row_ror:2 row_mask:0xf bank_mask:0xf
    v_add_f32_dpp v57, v57, v57 row_ror:2 row_mask:0xf bank_mask:0xf
    s_nop 0
    v_add_f32_dpp v56, v56, v56 row_ror:4 row_mask:0xf bank_mask:0xf
    v_add_f32_dpp v57, v57, v57 row_ror:4 row_mask:0xf bank_mask:0xf
    s_nop 0
    v_add_f32_dpp v56, v56, v56 row_ror:8 row_mask:0xf bank_mask:0xf
    v_add_f32_dpp v57, v57, v57 row_ror:8 row_mask:0xf bank_mask:0xf
    s_nop 0
    v_add_f32_dpp v56, v56, v56 row_bcast:15 row_mask:0xa bank_mask:0xf
    v_add_f32_dpp v57, v57, v57 row_bcast:15 row_mask:0xa bank_mask:0xf
    s_nop 0
    v_add_f32_dpp v56, v56, v56 row_bcast:31 row_mask:0xc bank_mask:0xf
    v_add_f32_dpp v57, v57, v57 row_bcast:31 row_mask:0xc bank_mask:0xf
    v_readlane_b32 s58, v56, 63
    v_readlane_b32 s59, v57, 63
    v_mov_b32 v58, 0x3b000000
    v_mul_f32 v56, s58, v58
    v_mul_f32 v57, s59, v58
    v_fma_f32 v57, -v56, v56, v57
    v_add_f32 v56, s11, v56
    v_max_f32 v57, 0, v57
    v_cvt_pk_bf16_f32 v57, v56, v57
    v_lshlrev_b32 v56, 16, v57
    v_and_b32 v57, 0xffff0000, v57
    v_add_f32 v57, 0x3727c5ac, v57
    v_sub_f32 v20, v20, v56
    v_sub_f32 v21, v21, v56
    v_sub_f32 v22, v22, v56
    v_sub_f32 v23, v23, v56
    v_cvt_pk_bf16_f32 v57, v57, v57
    v_lshlrev_b32 v57, 16, v57
    v_sub_f32 v24, v24, v56
    v_sub_f32 v25, v25, v56
    v_sub_f32 v26, v26, v56
    v_sub_f32 v27, v27, v56
    v_sqrt_f32 v57, v57
    v_cvt_pk_bf16_f32 v16, v20, v21
    v_cvt_pk_bf16_f32 v17, v22, v23
    v_cvt_pk_bf16_f32 v18, v24, v25
    v_cvt_pk_bf16_f32 v19, v26, v27
    v_cvt_pk_bf16_f32 v57, v57, v57
    v_lshlrev_b32 v57, 16, v57
    v_rcp_f32 v57, v57
    v_lshlrev_b32 v20, 16, v16
    v_and_b32 v21, 0xffff0000, v16
    v_lshlrev_b32 v22, 16, v17
    v_and_b32 v23, 0xffff0000, v17
    v_lshlrev_b32 v24, 16, v18
    v_and_b32 v25, 0xffff0000, v18
    v_lshlrev_b32 v26, 16, v19
    v_and_b32 v27, 0xffff0000, v19
    v_mul_f32 v20, v20, v57
    v_mul_f32 v21, v21, v57
    v_mul_f32 v22, v22, v57
    v_mul_f32 v23, v23, v57
    v_mul_f32 v24, v24, v57
    v_mul_f32 v25, v25, v57
    v_mul_f32 v26, v26, v57
    v_mul_f32 v27, v27, v57
    v_cvt_pk_bf16_f32 v16, v20, v21
    v_cvt_pk_bf16_f32 v17, v22, v23
    v_cvt_pk_bf16_f32 v18, v24, v25
    v_cvt_pk_bf16_f32 v19, v26, v27
    ds_write_b128 v8, v[16:19]
    s_lshl_b32 s15, s5, 6
    v_lshl_add_u32 v8, v6, 3, s15
    ds_read_b64 v[28:29], v8 offset:4096
    v_lshlrev_b32 v6, 4, v2
    v_lshl_add_u32 v6, v12, 5, v6
    s_add_u32 s14, s57, 0x30100
    s_add_u32 s62, s14, 0x90000
    s_add_u32 s63, s5, 32
    s_waitcnt lgkmcnt(0)

    s_add_u32 s8, s6, 1
    s_and_b32 s7, s8, 0xfff
    s_and_b32 s94, s8, 0x3ff
    s_and_b32 s90, s8, 0xff
    s_mul_i32 s90, s90, 0x01010101
    s_mov_b32 s91, s90
    s_lshl_b32 s92, s4, 13
    s_add_u32 s92, s92, 0x30000
    v_lshlrev_b32 v12, 9, v0
    v_mov_b32 v13, s90
    v_perm_b32 v44, v28, v28, v36
    v_perm_b32 v45, v28, v28, v38
    v_perm_b32 v46, v28, v28, v40
    v_perm_b32 v47, v28, v28, v42
    v_perm_b32 v48, v28, v28, v37
    v_perm_b32 v49, v28, v28, v39
    v_perm_b32 v50, v28, v28, v41
    v_perm_b32 v51, v28, v28, v43
    s_waitcnt vmcnt(4)
    v_mfma_f32_16x16x32_bf16 v[52:55], v[44:47], v[64:67], 0
    v_perm_b32 v44, v29, v29, v36
    v_perm_b32 v45, v29, v29, v38
    v_perm_b32 v46, v29, v29, v40
    v_perm_b32 v47, v29, v29, v42
    s_waitcnt vmcnt(3)
    v_mfma_f32_16x16x32_bf16 v[52:55], v[48:51], v[68:71], v[52:55]
    v_perm_b32 v48, v29, v29, v37
    v_perm_b32 v49, v29, v29, v39
    v_perm_b32 v50, v29, v29, v41
    v_perm_b32 v51, v29, v29, v43
    s_waitcnt vmcnt(2)
    v_mfma_f32_16x16x32_bf16 v[52:55], v[44:47], v[72:75], v[52:55]
    s_waitcnt vmcnt(1)
    v_mfma_f32_16x16x32_bf16 v[52:55], v[48:51], v[76:79], v[52:55]
    s_nop 7
    v_mov_b32 v56, v52
    v_mov_b32 v57, v53
    v_mov_b32 v58, v54
    v_mov_b32 v59, v55
    v_permlane32_swap_b32 v52, v56
    v_permlane32_swap_b32 v53, v57
    v_permlane32_swap_b32 v54, v58
    v_permlane32_swap_b32 v55, v59
    v_add_f32_dpp v52, v56, v52 row_ror:8 row_mask:0xf bank_mask:0xf
    v_add_f32_dpp v53, v57, v53 row_ror:8 row_mask:0xf bank_mask:0xf
    v_add_f32_dpp v54, v58, v54 row_ror:8 row_mask:0xf bank_mask:0xf
    v_add_f32_dpp v55, v59, v55 row_ror:8 row_mask:0xf bank_mask:0xf
    v_mov_b32 v56, 0xfffffc00
    v_add_u32 v52, 0x200, v52
    v_add_u32 v53, 0x200, v53
    v_add_u32 v54, 0x200, v54
    v_add_u32 v55, 0x200, v55
    v_and_or_b32 v52, v52, v56, s94
    v_and_or_b32 v53, v53, v56, s94
    v_and_or_b32 v54, v54, v56, s94
    v_and_or_b32 v55, v55, v56, s94
    s_mov_b64 exec, 0x00ff00ff
    buffer_store_dwordx4 v[52:55], v6, s[40:43], s14 offen
    s_add_u32 s15, s92, s63
    s_mov_b64 exec, 0xffff
    buffer_store_byte v13, v12, s[40:43], s15 offen
    s_mov_b64 exec, -1
    s_mov_b64 exec, 0x00ff00ff
    buffer_store_dwordx4 v[52:55], v6, s[40:43], s62 offen sc1
    s_mov_b64 exec, -1
    v_mov_b32 v8, 12464
    v_mov_b32 v9, 1
    s_mov_b64 exec, 1
    ds_add_u32 v8, v9
    s_mov_b64 exec, -1
    v_lshlrev_b32 v7, 9, v2
    v_lshl_add_u32 v7, v3, 4, v7
    v_mov_b32 v14, 0x7fffff00
    v_cmp_eq_u32 vcc, 3, v2
    s_nop 1
    v_cndmask_b32 v14, v4, v14, vcc
    v_mov_b32 v12, s94
    v_cndmask_b32 v12, v12, 0, vcc
    v_lshlrev_b32 v13, 3, v3
    v_lshl_add_u32 v13, v2, 1, v13
    s_lshl_b32 s14, s4, 13
    s_add_u32 s58, s14, 0x30100
    s_add_u32 s59, s58, 4096
    s_add_u32 s14, s14, 0x10000
    s_add_u32 s15, s14, 4096

    s_add_u32 s93, s92, 8192
HINT_9:
    s_load_dwordx16 s[16:31], s[40:41], s92
    s_add_u32 s92, s92, 512
    s_sleep 3
    s_waitcnt lgkmcnt(0)
    s_cmp_ge_u32 s92, s93
    s_cbranch_scc1 HINTX_10
    s_xor_b64 s[16:17], s[16:17], s[90:91]
    s_xor_b64 s[18:19], s[18:19], s[90:91]
    s_xor_b64 s[20:21], s[20:21], s[90:91]
    s_xor_b64 s[22:23], s[22:23], s[90:91]
    s_xor_b64 s[24:25], s[24:25], s[90:91]
    s_xor_b64 s[26:27], s[26:27], s[90:91]
    s_or_b64 s[16:17], s[16:17], s[18:19]
    s_or_b64 s[20:21], s[20:21], s[22:23]
    s_or_b64 s[24:25], s[24:25], s[26:27]
    s_or_b64 s[16:17], s[16:17], s[20:21]
    s_or_b64 s[16:17], s[16:17], s[24:25]
    s_cbranch_scc1 HINT_9
HINTX_10:
    s_mov_b32 s9, 0
P_loop:
    s_and_b32 s10, s9, 31
    s_cmp_eq_u32 s10, 31
    s_cselect_b32 s10, 0x90000, 0
    v_add_u32 v9, s10, v4
    v_add_u32 v10, s10, v14
    v_add_u32 v11, s10, v7
    buffer_load_dwordx4 v[64:67], v9, s[40:43], s14 offen offset:0 sc1
    buffer_load_dwordx4 v[68:71], v10, s[40:43], s14 offen offset:1024 sc1
    buffer_load_dwordx4 v[72:75], v9, s[40:43], s14 offen offset:2048 sc1
    buffer_load_dwordx4 v[76:79], v10, s[40:43], s14 offen offset:3072 sc1
    buffer_load_dwordx4 v[80:83], v9, s[40:43], s15 offen offset:0 sc1
    buffer_load_dwordx4 v[84:87], v10, s[40:43], s15 offen offset:1024 sc1
    buffer_load_dwordx4 v[88:91], v9, s[40:43], s15 offen offset:2048 sc1
    buffer_load_dwordx4 v[92:95], v10, s[40:43], s15 offen offset:3072 sc1
    buffer_load_dwordx4 v[96:99], v11, s[40:43], s58 offen offset:0 sc1
    buffer_load_dwordx4 v[100:103], v11, s[40:43], s58 offen offset:2048 sc1
    buffer_load_dwordx4 v[104:107], v11, s[40:43], s59 offen offset:0 sc1
    buffer_load_dwordx4 v[108:111], v11, s[40:43], s59 offen offset:2048 sc1
    s_cmp_lg_u32 s9, 0
    s_cbranch_scc1 P_nogate
    v_mov_b32 v8, 12444
    v_mov_b32 v5, 1
    s_mov_b64 exec, 1
    ds_add_u32 v8, v5
    s_mov_b64 exec, -1
P_nogate:
    s_add_u32 s9, s9, 1
    s_waitcnt vmcnt(11)
    v_xor_b32 v64, s94, v64
    v_xor_b32 v65, s94, v65
    v_xor_b32 v66, s94, v66
    v_xor_b32 v67, s94, v67
    v_or3_b32 v6, v64, v65, v66
    v_or_b32 v6, v6, v67
    s_waitcnt vmcnt(10)
    v_xor_b32 v68, v12, v68
    v_xor_b32 v69, v12, v69
    v_xor_b32 v70, v12, v70
    v_xor_b32 v71, v12, v71
    v_or3_b32 v6, v6, v68, v69
    v_or3_b32 v6, v6, v70, v71
    s_waitcnt vmcnt(9)
    v_xor_b32 v72, s94, v72
    v_xor_b32 v73, s94, v73
    v_xor_b32 v74, s94, v74
    v_xor_b32 v75, s94, v75
    v_or3_b32 v6, v6, v72, v73
    v_or3_b32 v6, v6, v74, v75
    s_waitcnt vmcnt(8)
    v_xor_b32 v76, v12, v76
    v_xor_b32 v77, v12, v77
    v_xor_b32 v78, v12, v78
    v_xor_b32 v79, v12, v79
    v_or3_b32 v6, v6, v76, v77
    v_or3_b32 v6, v6, v78, v79
    s_waitcnt vmcnt(7)
    v_xor_b32 v80, s94, v80
    v_xor_b32 v81, s94, v81
    v_xor_b32 v82, s94, v82
    v_xor_b32 v83, s94, v83
    v_or3_b32 v6, v6, v80, v81
    v_or3_b32 v6, v6, v82, v83
    s_waitcnt vmcnt(6)
    v_xor_b32 v84, v12, v84
    v_xor_b32 v85, v12, v85
    v_xor_b32 v86, v12, v86
    v_xor_b32 v87, v12, v87
    v_or3_b32 v6, v6, v84, v85
    v_or3_b32 v6, v6, v86, v87
    s_waitcnt vmcnt(5)
    v_xor_b32 v88, s94, v88
    v_xor_b32 v89, s94, v89
    v_xor_b32 v90, s94, v90
    v_xor_b32 v91, s94, v91
    v_or3_b32 v6, v6, v88, v89
    v_or3_b32 v6, v6, v90, v91
    s_waitcnt vmcnt(4)
    v_xor_b32 v92, v12, v92
    v_xor_b32 v93, v12, v93
    v_xor_b32 v94, v12, v94
    v_xor_b32 v95, v12, v95
    v_or3_b32 v6, v6, v92, v93
    v_or3_b32 v6, v6, v94, v95
    s_waitcnt vmcnt(3)
    v_xor_b32 v96, s94, v96
    v_xor_b32 v97, s94, v97
    v_xor_b32 v98, s94, v98
    v_xor_b32 v99, s94, v99
    v_or3_b32 v6, v6, v96, v97
    v_or3_b32 v6, v6, v98, v99
    s_waitcnt vmcnt(2)
    v_xor_b32 v100, s94, v100
    v_xor_b32 v101, s94, v101
    v_xor_b32 v102, s94, v102
    v_xor_b32 v103, s94, v103
    v_or3_b32 v6, v6, v100, v101
    v_or3_b32 v6, v6, v102, v103
    s_waitcnt vmcnt(1)
    v_xor_b32 v104, s94, v104
    v_xor_b32 v105, s94, v105
    v_xor_b32 v106, s94, v106
    v_xor_b32 v107, s94, v107
    v_or3_b32 v6, v6, v104, v105
    v_or3_b32 v6, v6, v106, v107
    s_waitcnt vmcnt(0)
    v_xor_b32 v108, s94, v108
    v_xor_b32 v109, s94, v109
    v_xor_b32 v110, s94, v110
    v_xor_b32 v111, s94, v111
    v_or3_b32 v6, v6, v108, v109
    v_or3_b32 v6, v6, v110, v111
    v_and_b32 v6, 0x3ff, v6
    v_cmp_ne_u32 vcc, 0, v6
    s_cbranch_vccz P_ok
    s_mov_b64 exec, vcc
    s_cmp_lt_u32 s9, 200000
    s_cbranch_scc1 P_loop
P_ok:
    s_mov_b64 exec, -1
    v_pk_add_f32 v[96:97], v[96:97], v[100:101]
    v_pk_add_f32 v[104:105], v[104:105], v[108:109]
    v_pk_add_f32 v[98:99], v[98:99], v[102:103]
    v_pk_add_f32 v[106:107], v[106:107], v[110:111]
    v_pk_add_f32 v[24:25], v[64:65], v[72:73]
    v_pk_add_f32 v[32:33], v[80:81], v[88:89]
    v_pk_add_f32 v[26:27], v[66:67], v[74:75]
    v_pk_add_f32 v[34:35], v[82:83], v[90:91]
    v_pk_add_f32 v[28:29], v[68:69], v[76:77]
    v_pk_add_f32 v[36:37], v[84:85], v[92:93]
    v_pk_add_f32 v[30:31], v[70:71], v[78:79]
    v_pk_add_f32 v[38:39], v[86:87], v[94:95]
    v_pk_add_f32 v[96:97], v[96:97], v[104:105]
    v_pk_add_f32 v[98:99], v[98:99], v[106:107]
    v_pk_add_f32 v[24:25], v[24:25], v[32:33]
    v_pk_add_f32 v[26:27], v[26:27], v[34:35]
    v_pk_add_f32 v[28:29], v[28:29], v[36:37]
    v_pk_add_f32 v[30:31], v[30:31], v[38:39]
    v_permlane32_swap_b32 v96, v98
    v_permlane32_swap_b32 v97, v99
    v_add_f32 v96, v96, v98
    v_add_f32 v97, v97, v99
    s_nop 1
    v_permlane16_swap_b32 v96, v97
    v_add_f32 v96, v96, v97
    v_cvt_pk_bf16_f32 v20, v24, v25
    v_cvt_pk_bf16_f32 v21, v26, v27
    v_cvt_pk_bf16_f32 v22, v28, v29
    v_cvt_pk_bf16_f32 v23, v30, v31
    v_cvt_pk_bf16_f32 v96, v96, v96
    v_lshlrev_b32 v6, 3, v0
    ds_write_b64 v6, v[20:21] offset:0
    ds_write_b64 v6, v[22:23] offset:512
    ds_write_b16 v13, v96 offset:896
    v_mov_b32 v7, 12416
    v_mov_b32 v8, s7
    ds_write_b32 v7, v8 offset:20
    v_mov_b32 v8, 1
    ds_write_b32 v7, v8
    s_and_b32 s12, s5, 8
    s_add_u32 s12, s12, s4
    s_lshl_b32 s12, s12, 7
    s_and_b32 s13, s5, 7
    s_lshl_b32 s13, s13, 4
    s_add_u32 s12, s12, s13
    s_lshr_b32 s13, s12, 9
    s_lshl_b32 s13, s13, 7
    s_bfe_u32 s14, s12, 0x40004
    s_lshl_b32 s14, s14, 3
    s_add_u32 s13, s13, s14
    s_bfe_u32 s14, s12, 0x10008
    s_lshl_b32 s14, s14, 2
    s_add_u32 s13, s13, s14
    s_lshl_b32 s13, s13, 1
    v_lshrrev_b32 v9, 4, v0
    v_lshlrev_b32 v9, 1, v9
    v_lshlrev_b32 v10, 11, v0
    buffer_load_ushort v11, v9, s[44:47], s13 offen
    buffer_load_ushort v12, v9, s[48:51], s13 offen
    s_add_u32 s14, s12, 0x140000
    s_add_u32 s15, s14, 0x20000
    s_add_u32 s56, s12, 0x180000

    v_mov_b32 v6, 12432
    s_mov_b32 s9, 0
SPIN_11:
    ds_read_b32 v7, v6
    s_add_u32 s9, s9, 1
    s_cmp_gt_u32 s9, 200000
    s_cbranch_scc1 SPINX_12
    s_waitcnt lgkmcnt(0)
    v_readfirstlane_b32 s10, v7
    s_cmp_ge_u32 s10, 2
    s_cbranch_scc1 SPINX_12
    s_sleep 2
    s_branch SPIN_11
SPINX_12:
    s_waitcnt lgkmcnt(0)
    s_mov_b32 s9, 0
POLL_13:
    buffer_load_dwordx4 v[72:75], v10, s[40:43], s56 offen sc1
    s_add_u32 s9, s9, 1
    s_waitcnt vmcnt(0)
    v_xor_b32 v72, s7, v72
    v_xor_b32 v73, s7, v73
    v_xor_b32 v74, s7, v74
    v_xor_b32 v75, s7, v75
    v_or3_b32 v6, v72, v73, v74
    v_or_b32 v6, v6, v75
    v_and_b32 v6, 0xfff, v6
    v_cmp_ne_u32 vcc, 0, v6
    s_cbranch_vccz POLLX_14
    s_mov_b64 exec, vcc
    s_cmp_gt_u32 s9, 200000
    s_cbranch_scc1 POLLX_14
    s_sleep 1
    s_branch POLL_13
POLLX_14:
    s_mov_b64 exec, -1
    v_permlane32_swap_b32 v72, v74
    v_permlane32_swap_b32 v73, v75
    v_add_f32 v72, v72, v74
    v_add_f32 v73, v73, v75
    s_nop 1
    v_permlane16_swap_b32 v72, v73
    v_add_f32 v72, v72, v73
    s_nop 1
    v_add_f32_dpp v72, v72, v72 row_ror:8 row_mask:0xf bank_mask:0xf
    s_nop 1
    v_add_f32_dpp v72, v72, v72 row_ror:4 row_mask:0xf bank_mask:0xf
    s_nop 1
    v_add_f32_dpp v72, v72, v72 row_ror:2 row_mask:0xf bank_mask:0xf
    s_nop 1
    v_add_f32_dpp v72, v72, v72 row_ror:1 row_mask:0xf bank_mask:0xf
    v_lshlrev_b32 v11, 16, v11
    v_lshlrev_b32 v12, 16, v12
    v_cvt_pk_bf16_f32 v72, v72, v72
    v_lshlrev_b32 v72, 16, v72
    v_add_f32 v72, v72, v12
    v_cvt_pk_bf16_f32 v72, v72, v72
    v_lshlrev_b32 v72, 16, v72
    v_mul_f32 v13, 0xbfb8aa3b, v72
    v_exp_f32 v13, v13
    s_nop 0
    v_add_f32 v13, 1.0, v13
    v_rcp_f32 v13, v13
    s_nop 0
    v_mul_f32 v13, v72, v13
    v_cvt_pk_bf16_f32 v13, v13, v13
    v_lshlrev_b32 v13, 16, v13
    s_mov_b32 s9, 0
POLL_15:
    buffer_load_dwordx4 v[64:67], v10, s[40:43], s14 offen sc1
    buffer_load_dwordx4 v[68:71], v10, s[40:43], s15 offen sc1
    s_add_u32 s9, s9, 1
    s_waitcnt vmcnt(0)
    v_xor_b32 v64, s7, v64
    v_xor_b32 v65, s7, v65
    v_xor_b32 v66, s7, v66
    v_xor_b32 v67, s7, v67
    v_xor_b32 v68, s7, v68
    v_xor_b32 v69, s7, v69
    v_xor_b32 v70, s7, v70
    v_xor_b32 v71, s7, v71
    v_or3_b32 v6, v64, v65, v66
    v_or3_b32 v6, v6, v67, v68
    v_or3_b32 v6, v6, v69, v70
    v_or_b32 v6, v6, v71
    v_and_b32 v6, 0xfff, v6
    v_cmp_ne_u32 vcc, 0, v6
    s_cbranch_vccz POLLX_16
    s_mov_b64 exec, vcc
    s_cmp_gt_u32 s9, 200000
    s_cbranch_scc1 POLLX_16
    s_branch POLL_15
POLLX_16:
    s_mov_b64 exec, -1
    v_add_f32 v64, v64, v68
    v_add_f32 v65, v65, v69
    v_add_f32 v66, v66, v70
    v_add_f32 v67, v67, v71
    s_nop 0
    v_permlane32_swap_b32 v64, v66
    v_permlane32_swap_b32 v65, v67
    v_add_f32 v64, v64, v66
    v_add_f32 v65, v65, v67
    s_nop 1
    v_permlane16_swap_b32 v64, v65
    v_add_f32 v64, v64, v65
    s_nop 1
    v_add_f32_dpp v64, v64, v64 row_ror:8 row_mask:0xf bank_mask:0xf
    s_nop 1
    v_add_f32_dpp v64, v64, v64 row_ror:4 row_mask:0xf bank_mask:0xf
    s_nop 1
    v_add_f32_dpp v64, v64, v64 row_ror:2 row_mask:0xf bank_mask:0xf
    s_nop 1
    v_add_f32_dpp v64, v64, v64 row_ror:1 row_mask:0xf bank_mask:0xf
    v_cvt_pk_bf16_f32 v64, v64, v64
    v_lshlrev_b32 v64, 16, v64
    v_mul_f32 v64, v64, v13
    v_cvt_pk_bf16_f32 v64, v64, v64
    v_lshlrev_b32 v64, 16, v64
    v_add_f32 v64, v64, v11
    v_cvt_pk_bf16_f32 v64, v64, v64
    s_mov_b32 exec_lo, 0x00010001
    s_mov_b32 exec_hi, 0x00010001
    buffer_store_short v64, v9, s[52:55], s13 offen
    s_cmp_lg_u32 s2, 0
    s_cbranch_scc1 L_fin
    s_mov_b64 exec, 1
    v_mov_b32 v6, 0
    v_mov_b32 v7, s8
    buffer_store_dword v7, v6, s[40:43], 0 offen

L_fin:
    s_endpgm
R_K:
    v_mov_b32 v8, 12440
    v_mov_b32 v9, 1
    s_mov_b64 exec, 1
    ds_add_u32 v8, v9
    s_mov_b64 exec, -1
    s_mov_b32 s42, 0x10000000
    s_mov_b32 s43, 0x20000
    s_mov_b32 s60, 0x05040100
    s_mov_b32 s61, 0x07060302
    v_mov_b32 v15, 0xfffff000

    v_lshrrev_b32 v6, 2, v3
    s_mov_b32 s52, 0xaaaaaaaa
    s_mov_b32 s53, 0xaaaaaaaa
    s_mov_b32 s54, 0xcccccccc
    s_mov_b32 s55, 0xcccccccc
    v_lshlrev_b32 v10, 2, v6
    v_mov_b32 v12, 1
    v_lshlrev_b32 v11, 6, v6
    v_lshl_add_u32 v11, v2, 2, v11
    s_lshl_b32 s15, s56, 4
    v_add_u32 v11, s15, v11
    v_lshlrev_b32 v13, 6, v6
    v_lshl_add_u32 v13, v2, 4, v13
    v_bfe_u32 v4, v0, 1, 1
    v_lshl_add_u32 v13, v4, 8, v13
    v_and_b32 v4, 1, v0
    v_lshl_add_u32 v13, v4, 3, v13
    s_lshl_b32 s15, s56, 9
    v_add_u32 v13, s15, v13
    s_lshl_b32 s15, s56, 2
    s_add_u32 s15, s15, 12448
    v_mov_b32 v14, s15
    v_mov_b32 v4, 12424
    v_mov_b32 v7, 12420

    s_waitcnt vmcnt(2)
    v_mov_b32 v8, 12444
    v_mov_b32 v9, 1
    s_mov_b64 exec, 1
    ds_add_u32 v8, v9
    s_mov_b64 exec, -1
    v_mov_b32 v8, 12416
    s_mov_b32 s9, 0
SPR_17:
    ds_read_b32 v9, v8
    ds_read_b128 v[60:63], v5 offset:0
    ds_read_b32 v1, v8 offset:20
    s_add_u32 s9, s9, 1
    s_waitcnt lgkmcnt(2)
    v_readfirstlane_b32 s10, v9
    s_cmp_ge_u32 s10, 1
    s_cbranch_scc1 SPRX_18
    s_sleep 1
    s_waitcnt lgkmcnt(0)
    s_cmp_lt_u32 s9, 200000
    s_cbranch_scc1 SPR_17
SPRX_18:
    s_waitcnt lgkmcnt(0)
    s_waitcnt vmcnt(12)
    v_mfma_f32_16x16x32_bf16 v[32:35], v[64:67], v[60:63], 0
    v_mfma_f32_16x16x32_bf16 v[36:39], v[68:71], v[60:63], 0
    v_mfma_f32_16x16x32_bf16 v[40:43], v[72:75], v[60:63], 0
    v_mfma_f32_16x16x32_bf16 v[44:47], v[76:79], v[60:63], 0
    s_waitcnt vmcnt(8)
    v_mfma_f32_16x16x32_bf16 v[64:67], v[80:83], v[60:63], 0
    v_mfma_f32_16x16x32_bf16 v[68:71], v[84:87], v[60:63], 0
    v_mfma_f32_16x16x32_bf16 v[72:75], v[88:91], v[60:63], 0
    v_mfma_f32_16x16x32_bf16 v[76:79], v[92:95], v[60:63], 0
    v_mov_b32_dpp v16, v32 quad_perm:[0,0,0,0] row_mask:0xf bank_mask:0xf
    v_mov_b32_dpp v17, v36 quad_perm:[0,0,0,0] row_mask:0xf bank_mask:0xf
    v_mov_b32_dpp v18, v40 quad_perm:[0,0,0,0] row_mask:0xf bank_mask:0xf
    v_mov_b32_dpp v19, v44 quad_perm:[0,0,0,0] row_mask:0xf bank_mask:0xf
    v_add_f32_dpp v16, v33, v16 quad_perm:[1,1,1,1] row_mask:0xf bank_mask:0xf
    v_add_f32_dpp v17, v37, v17 quad_perm:[1,1,1,1] row_mask:0xf bank_mask:0xf
    v_add_f32_dpp v18, v41, v18 quad_perm:[1,1,1,1] row_mask:0xf bank_mask:0xf
    v_add_f32_dpp v19, v45, v19 quad_perm:[1,1,1,1] row_mask:0xf bank_mask:0xf
    v_add_f32_dpp v16, v34, v16 quad_perm:[2,2,2,2] row_mask:0xf bank_mask:0xf
    v_add_f32_dpp v17, v38, v17 quad_perm:[2,2,2,2] row_mask:0xf bank_mask:0xf
    v_add_f32_dpp v18, v42, v18 quad_perm:[2,2,2,2] row_mask:0xf bank_mask:0xf
    v_add_f32_dpp v19, v46, v19 quad_perm:[2,2,2,2] row_mask:0xf bank_mask:0xf
    v_add_f32_dpp v16, v35, v16 quad_perm:[3,3,3,3] row_mask:0xf bank_mask:0xf
    v_add_f32_dpp v17, v39, v17 quad_perm:[3,3,3,3] row_mask:0xf bank_mask:0xf
    v_add_f32_dpp v18, v43, v18 quad_perm:[3,3,3,3] row_mask:0xf bank_mask:0xf
    v_add_f32_dpp v19, v47, v19 quad_perm:[3,3,3,3] row_mask:0xf bank_mask:0xf
    s_waitcnt vmcnt(4)
    v_mfma_f32_16x16x32_bf16 v[80:83], v[96:99], v[60:63], 0
    v_mfma_f32_16x16x32_bf16 v[84:87], v[100:103], v[60:63], 0
    v_mfma_f32_16x16x32_bf16 v[88:91], v[104:107], v[60:63], 0
    v_mfma_f32_16x16x32_bf16 v[92:95], v[108:111], v[60:63], 0
    v_mov_b32_dpp v20, v64 quad_perm:[0,0,0,0] row_mask:0xf bank_mask:0xf
    v_mov_b32_dpp v21, v68 quad_perm:[0,0,0,0] row_mask:0xf bank_mask:0xf
    v_mov_b32_dpp v22, v72 quad_perm:[0,0,0,0] row_mask:0xf bank_mask:0xf
    v_mov_b32_dpp v23, v76 quad_perm:[0,0,0,0] row_mask:0xf bank_mask:0xf
    v_add_f32_dpp v20, v65, v20 quad_perm:[1,1,1,1] row_mask:0xf bank_mask:0xf
    v_add_f32_dpp v21, v69, v21 quad_perm:[1,1,1,1] row_mask:0xf bank_mask:0xf
    v_add_f32_dpp v22, v73, v22 quad_perm:[1,1,1,1] row_mask:0xf bank_mask:0xf
    v_add_f32_dpp v23, v77, v23 quad_perm:[1,1,1,1] row_mask:0xf bank_mask:0xf
    v_add_f32_dpp v20, v66, v20 quad_perm:[2,2,2,2] row_mask:0xf bank_mask:0xf
    v_add_f32_dpp v21, v70, v21 quad_perm:[2,2,2,2] row_mask:0xf bank_mask:0xf
    v_add_f32_dpp v22, v74, v22 quad_perm:[2,2,2,2] row_mask:0xf bank_mask:0xf
    v_add_f32_dpp v23, v78, v23 quad_perm:[2,2,2,2] row_mask:0xf bank_mask:0xf
    v_add_f32_dpp v20, v67, v20 quad_perm:[3,3,3,3] row_mask:0xf bank_mask:0xf
    v_add_f32_dpp v21, v71, v21 quad_perm:[3,3,3,3] row_mask:0xf bank_mask:0xf
    v_add_f32_dpp v22, v75, v22 quad_perm:[3,3,3,3] row_mask:0xf bank_mask:0xf
    v_add_f32_dpp v23, v79, v23 quad_perm:[3,3,3,3] row_mask:0xf bank_mask:0xf
    s_waitcnt vmcnt(0)
    v_mfma_f32_16x16x32_bf16 v[96:99], v[112:115], v[60:63], 0
    v_mfma_f32_16x16x32_bf16 v[100:103], v[116:119], v[60:63], 0
    v_mfma_f32_16x16x32_bf16 v[104:107], v[120:123], v[60:63], 0
    v_mfma_f32_16x16x32_bf16 v[108:111], v[124:127], v[60:63], 0
    v_mov_b32_dpp v24, v80 quad_perm:[0,0,0,0] row_mask:0xf bank_mask:0xf
    v_mov_b32_dpp v25, v84 quad_perm:[0,0,0,0] row_mask:0xf bank_mask:0xf
    v_mov_b32_dpp v26, v88 quad_perm:[0,0,0,0] row_mask:0xf bank_mask:0xf
    v_mov_b32_dpp v27, v92 quad_perm:[0,0,0,0] row_mask:0xf bank_mask:0xf
    v_add_f32_dpp v24, v81, v24 quad_perm:[1,1,1,1] row_mask:0xf bank_mask:0xf
    v_add_f32_dpp v25, v85, v25 quad_perm:[1,1,1,1] row_mask:0xf bank_mask:0xf
    v_add_f32_dpp v26, v89, v26 quad_perm:[1,1,1,1] row_mask:0xf bank_mask:0xf
    v_add_f32_dpp v27, v93, v27 quad_perm:[1,1,1,1] row_mask:0xf bank_mask:0xf
    v_add_f32_dpp v24, v82, v24 quad_perm:[2,2,2,2] row_mask:0xf bank_mask:0xf
    v_add_f32_dpp v25, v86, v25 quad_perm:[2,2,2,2] row_mask:0xf bank_mask:0xf
    v_add_f32_dpp v26, v90, v26 quad_perm:[2,2,2,2] row_mask:0xf bank_mask:0xf
    v_add_f32_dpp v27, v94, v27 quad_perm:[2,2,2,2] row_mask:0xf bank_mask:0xf
    v_add_f32_dpp v24, v83, v24 quad_perm:[3,3,3,3] row_mask:0xf bank_mask:0xf
    v_add_f32_dpp v25, v87, v25 quad_perm:[3,3,3,3] row_mask:0xf bank_mask:0xf
    v_add_f32_dpp v26, v91, v26 quad_perm:[3,3,3,3] row_mask:0xf bank_mask:0xf
    v_add_f32_dpp v27, v95, v27 quad_perm:[3,3,3,3] row_mask:0xf bank_mask:0xf
    v_readfirstlane_b32 s7, v1
    v_mov_b32_dpp v28, v96 quad_perm:[0,0,0,0] row_mask:0xf bank_mask:0xf
    v_mov_b32_dpp v29, v100 quad_perm:[0,0,0,0] row_mask:0xf bank_mask:0xf
    v_mov_b32_dpp v30, v104 quad_perm:[0,0,0,0] row_mask:0xf bank_mask:0xf
    v_mov_b32_dpp v31, v108 quad_perm:[0,0,0,0] row_mask:0xf bank_mask:0xf
    v_add_f32_dpp v28, v97, v28 quad_perm:[1,1,1,1] row_mask:0xf bank_mask:0xf
    v_add_f32_dpp v29, v101, v29 quad_perm:[1,1,1,1] row_mask:0xf bank_mask:0xf
    v_add_f32_dpp v30, v105, v30 quad_perm:[1,1,1,1] row_mask:0xf bank_mask:0xf
    v_add_f32_dpp v31, v109, v31 quad_perm:[1,1,1,1] row_mask:0xf bank_mask:0xf
    v_add_f32_dpp v28, v98, v28 quad_perm:[2,2,2,2] row_mask:0xf bank_mask:0xf
    v_add_f32_dpp v29, v102, v29 quad_perm:[2,2,2,2] row_mask:0xf bank_mask:0xf
    v_add_f32_dpp v30, v106, v30 quad_perm:[2,2,2,2] row_mask:0xf bank_mask:0xf
    v_add_f32_dpp v31, v110, v31 quad_perm:[2,2,2,2] row_mask:0xf bank_mask:0xf
    v_add_f32_dpp v28, v99, v28 quad_perm:[3,3,3,3] row_mask:0xf bank_mask:0xf
    v_add_f32_dpp v29, v103, v29 quad_perm:[3,3,3,3] row_mask:0xf bank_mask:0xf
    v_add_f32_dpp v30, v107, v30 quad_perm:[3,3,3,3] row_mask:0xf bank_mask:0xf
    v_add_f32_dpp v31, v111, v31 quad_perm:[3,3,3,3] row_mask:0xf bank_mask:0xf
    v_cndmask_b32 v32, v16, v20, s[52:53]
    v_cndmask_b32 v36, v24, v28, s[52:53]
    v_cndmask_b32 v33, v17, v21, s[52:53]
    v_cndmask_b32 v37, v25, v29, s[52:53]
    v_cndmask_b32 v34, v18, v22, s[52:53]
    v_cndmask_b32 v38, v26, v30, s[52:53]
    v_cndmask_b32 v35, v19, v23, s[52:53]
    v_cndmask_b32 v39, v27, v31, s[52:53]
    v_cndmask_b32 v16, v32, v36, s[54:55]
    v_cndmask_b32 v17, v33, v37, s[54:55]
    v_cndmask_b32 v18, v34, v38, s[54:55]
    v_cndmask_b32 v19, v35, v39, s[54:55]
    s_mov_b32 s14, 0x3db504f3
    v_cvt_pk_bf16_f32 v32, v16, v17
    v_cvt_pk_bf16_f32 v33, v18, v19
    v_lshlrev_b32 v16, 16, v32
    v_and_b32 v17, 0xffff0000, v32
    v_lshlrev_b32 v18, 16, v33
    v_and_b32 v19, 0xffff0000, v33
    v_mul_f32 v16, s14, v16
    v_mul_f32 v17, s14, v17
    v_mul_f32 v18, s14, v18
    v_mul_f32 v19, s14, v19
    v_cvt_pk_bf16_f32 v32, v16, v17
    v_cvt_pk_bf16_f32 v33, v18, v19
    v_lshlrev_b32 v16, 16, v32
    v_and_b32 v17, 0xffff0000, v32
    v_lshlrev_b32 v18, 16, v33
    v_and_b32 v19, 0xffff0000, v33
    v_max3_f32 v8, v16, v17, v18
    v_max_f32 v8, v8, v19
    s_nop 1
    v_max_f32_dpp v8, v8, v8 quad_perm:[1,0,3,2] row_mask:0xf bank_mask:0xf
    s_nop 1
    v_max_f32_dpp v8, v8, v8 quad_perm:[2,3,0,1] row_mask:0xf bank_mask:0xf
    v_mov_b32 v9, v8
    s_nop 1
    v_permlane32_swap_b32 v8, v9
    v_max_f32 v8, v8, v9
    v_mov_b32 v9, v8
    s_nop 1
    v_permlane16_swap_b32 v8, v9
    v_max_f32 v8, v8, v9
    s_mov_b32 s14, 0x3fb8aa3b
    v_mul_f32 v9, s14, v8

    v_fma_f32 v16, v16, s14, -v9
    v_fma_f32 v17, v17, s14, -v9
    v_fma_f32 v18, v18, s14, -v9
    v_fma_f32 v19, v19, s14, -v9
    v_exp_f32 v16, v16
    v_exp_f32 v17, v17
    v_exp_f32 v18, v18
    v_exp_f32 v19, v19
    v_cvt_pk_bf16_f32 v32, v16, v17
    v_cvt_pk_bf16_f32 v33, v18, v19
    ds_write_b64 v13, v[32:33] offset:1024
    s_mov_b64 exec, 1
    ds_write_b32 v14, v12
    s_mov_b64 exec, -1
    v_add_f32 v16, v16, v17
    v_add_f32 v18, v18, v19
    v_add_f32 v16, v16, v18
    s_nop 1
    v_add_f32_dpp v16, v16, v16 quad_perm:[1,0,3,2] row_mask:0xf bank_mask:0xf
    s_nop 1
    v_add_f32_dpp v16, v16, v16 quad_perm:[2,3,0,1] row_mask:0xf bank_mask:0xf
    s_mov_b32 exec_lo, 0x11111111
    s_mov_b32 exec_hi, 0x11111111
    ds_write_b32 v11, v16 offset:12544
    ds_write_b32 v11, v8 offset:12800
    s_mov_b64 exec, 1
    ds_add_u32 v4, v12
    s_mov_b64 exec, -1

    s_lshl4_add_u32 s57, s4, s5
    s_cmp_ge_u32 s56, 2
    s_cbranch_scc1 K_ml
    s_setprio 3
    v_lshlrev_b32 v6, 16, v6
    v_and_b32 v7, 3, v3
    v_lshl_add_u32 v6, v7, 7, v6
    v_lshl_add_u32 v6, v2, 4, v6
    s_lshl_b32 s14, s57, 9
    s_lshl_b32 s15, s56, 6
    s_add_u32 s14, s14, s15
    s_add_u32 s14, s14, 0x40000
    s_add_u32 s15, s14, 0x90000
    s_lshl_b32 s13, s56, 10
    v_lshl_add_u32 v19, v0, 4, s13

    v_lshlrev_b32 v22, 2, v0
    v_mov_b32 v20, 12424
    s_mov_b32 s9, 0
SPIN_19:
    ds_read_b32 v21, v20
    s_add_u32 s9, s9, 1
    s_cmp_gt_u32 s9, 200000
    s_cbranch_scc1 SPINX_20
    s_waitcnt lgkmcnt(0)
    v_readfirstlane_b32 s10, v21
    s_cmp_ge_u32 s10, 4
    s_cbranch_scc1 SPINX_20
    s_branch SPIN_19
SPINX_20:
    s_waitcnt lgkmcnt(0)
    ds_read_b32 v24, v22 offset:12800
    ds_read_b32 v17, v22 offset:12544
    s_waitcnt lgkmcnt(0)
    v_max_f32_dpp v25, v24, v24 row_ror:4 row_mask:0xf bank_mask:0xf
    s_nop 1
    v_max_f32_dpp v25, v25, v25 row_ror:8 row_mask:0xf bank_mask:0xf
    v_sub_f32 v26, v24, v25
    v_mul_f32 v26, 0x3fb8aa3b, v26
    v_exp_f32 v26, v26
    s_nop 1
    v_mov_b32_dpp v28, v26 row_newbcast:0 row_mask:0xf bank_mask:0xf
    v_mov_b32_dpp v29, v26 row_newbcast:4 row_mask:0xf bank_mask:0xf
    v_mov_b32_dpp v30, v26 row_newbcast:8 row_mask:0xf bank_mask:0xf
    v_mov_b32_dpp v31, v26 row_newbcast:12 row_mask:0xf bank_mask:0xf
    v_mov_b32 v20, 12428
    s_mov_b32 s9, 0
SPR_21:
    ds_read_b32 v21, v20
    ds_read_b128 v[32:35], v19 offset:4096
    ds_read_b128 v[36:39], v19 offset:6144
    ds_read_b128 v[40:43], v19 offset:8192
    ds_read_b128 v[44:47], v19 offset:10240
    s_add_u32 s9, s9, 1
    s_waitcnt lgkmcnt(4)
    v_readfirstlane_b32 s10, v21
    s_cmp_ge_u32 s10, 4
    s_cbranch_scc1 SPRX_22
    s_waitcnt lgkmcnt(0)
    s_cmp_lt_u32 s9, 200000
    s_cbranch_scc1 SPR_21
SPRX_22:
    s_waitcnt lgkmcnt(3)
    v_mul_f32 v32, v28, v32
    v_mul_f32 v33, v28, v33
    v_mul_f32 v34, v28, v34
    v_mul_f32 v35, v28, v35
    s_waitcnt lgkmcnt(2)
    v_fmac_f32 v32, v29, v36
    v_fmac_f32 v33, v29, v37
    v_fmac_f32 v34, v29, v38
    v_fmac_f32 v35, v29, v39
    s_waitcnt lgkmcnt(1)
    v_fmac_f32 v32, v30, v40
    v_fmac_f32 v33, v30, v41
    v_fmac_f32 v34, v30, v42
    v_fmac_f32 v35, v30, v43
    s_waitcnt lgkmcnt(0)
    v_fmac_f32 v32, v31, v44
    v_fmac_f32 v33, v31, v45
    v_fmac_f32 v34, v31, v46
    v_fmac_f32 v35, v31, v47
    v_and_or_b32 v32, v32, v15, s7
    v_and_or_b32 v33, v33, v15, s7
    v_and_or_b32 v34, v34, v15, s7
    v_and_or_b32 v35, v35, v15, s7
    buffer_store_dwordx4 v[32:35], v6, s[40:43], s14 offen
    v_mov_b32 v8, 12432
    v_mov_b32 v9, 1
    s_mov_b64 exec, 1
    ds_add_u32 v8, v9
    s_mov_b64 exec, -1
    v_mov_b32 v8, 12432
    s_mov_b32 s9, 0
SPIN_23:
    ds_read_b32 v9, v8
    s_add_u32 s9, s9, 1
    s_cmp_gt_u32 s9, 200000
    s_cbranch_scc1 SPINX_24
    s_waitcnt lgkmcnt(0)
    v_readfirstlane_b32 s10, v9
    s_cmp_ge_u32 s10, 2
    s_cbranch_scc1 SPINX_24
    s_branch SPIN_23
SPINX_24:
    s_waitcnt lgkmcnt(0)
    buffer_store_dwordx4 v[32:35], v6, s[40:43], s15 offen sc1
    s_endpgm
K_ml:
    s_cmp_eq_u32 s56, 3
    s_cbranch_scc1 K_done
    v_lshlrev_b32 v22, 2, v0
    v_lshlrev_b32 v23, 2, v2
    v_lshlrev_b32 v7, 9, v3
    v_lshl_add_u32 v7, v2, 4, v7
    s_lshl_b32 s52, s4, 13
    s_and_b32 s53, s5, 7
    s_lshl_b32 s53, s53, 6
    s_add_u32 s52, s52, s53
    s_lshr_b32 s53, s5, 3
    s_lshl_b32 s53, s53, 16
    s_add_u32 s52, s52, s53
    s_add_u32 s52, s52, 0x80000
    s_add_u32 s53, s52, 0x90000

    v_lshlrev_b32 v22, 2, v0
    v_mov_b32 v20, 12424
    s_mov_b32 s9, 0
SPIN_25:
    ds_read_b32 v21, v20
    s_add_u32 s9, s9, 1
    s_cmp_gt_u32 s9, 200000
    s_cbranch_scc1 SPINX_26
    s_waitcnt lgkmcnt(0)
    v_readfirstlane_b32 s10, v21
    s_cmp_ge_u32 s10, 4
    s_cbranch_scc1 SPINX_26
    s_branch SPIN_25
SPINX_26:
    s_waitcnt lgkmcnt(0)
    ds_read_b32 v24, v22 offset:12800
    ds_read_b32 v17, v22 offset:12544
    s_waitcnt lgkmcnt(0)
    v_max_f32_dpp v25, v24, v24 row_ror:4 row_mask:0xf bank_mask:0xf
    s_nop 1
    v_max_f32_dpp v25, v25, v25 row_ror:8 row_mask:0xf bank_mask:0xf
    v_sub_f32 v26, v24, v25
    v_mul_f32 v26, 0x3fb8aa3b, v26
    v_exp_f32 v26, v26
    s_nop 0
    v_mul_f32 v17, v17, v26
    v_mov_b32 v16, v25
    s_nop 0
    v_add_f32_dpp v17, v17, v17 row_ror:8 row_mask:0xf bank_mask:0xf
    s_nop 1
    v_add_f32_dpp v17, v17, v17 row_ror:4 row_mask:0xf bank_mask:0xf
    s_nop 1
    v_add_f32_dpp v17, v17, v17 row_ror:2 row_mask:0xf bank_mask:0xf
    s_nop 1
    v_add_f32_dpp v17, v17, v17 row_ror:1 row_mask:0xf bank_mask:0xf
    v_and_or_b32 v24, v16, v15, s7
    v_and_or_b32 v25, v17, v15, s7
    v_and_or_b32 v26, v16, v15, s7
    v_and_or_b32 v27, v17, v15, s7
    buffer_store_dwordx4 v[24:27], v7, s[40:43], s52 offen
    buffer_store_dwordx4 v[24:27], v7, s[40:43], s53 offen sc1
K_done:
    s_endpgm
R_V:
    s_sub_u32 s56, s3, 5
    s_lshl2_add_u32 s13, s5, s56
    s_lshl_b32 s13, s13, 10
    s_lshl_b32 s12, s4, 23
    s_add_u32 s12, s12, s13
    s_add_u32 s12, s12, 7340032
    s_mov_b32 s15, 0x10000
    s_mov_b32 s46, 0x4000000
    v_lshlrev_b32 v4, 4, v0
    v_lshrrev_b32 v6, 2, v3
    v_lshlrev_b32 v13, 6, v6
    v_lshl_add_u32 v13, v2, 4, v13
    s_lshl_b32 s14, s56, 9
    v_add_u32 v13, s14, v13
    s_lshl_b32 s57, s56, 2
    s_add_u32 s57, s57, 12448
    s_lshl_b32 s14, s56, 11
    v_add_u32 v19, s14, v4
    v_mov_b32 v20, 1
    v_mov_b32 v21, 12428

    s_mov_b32 s42, 0x10000000
    s_mov_b32 s43, 0x20000
    s_mov_b32 s60, 0x05040100
    s_mov_b32 s61, 0x07060302
    v_mov_b32 v15, 0xfffff000

    s_waitcnt lgkmcnt(0)
    s_mov_b64 s[44:45], s[20:21]
    v_mov_b32 v8, 12440
    s_mov_b32 s9, 0
SPIN_27:
    ds_read_b32 v9, v8
    s_add_u32 s9, s9, 1
    s_cmp_gt_u32 s9, 200000
    s_cbranch_scc1 SPINX_28
    s_waitcnt lgkmcnt(0)
    v_readfirstlane_b32 s10, v9
    s_cmp_ge_u32 s10, 4
    s_cbranch_scc1 SPINX_28
    s_sleep 1
    s_branch SPIN_27
SPINX_28:
    s_waitcnt lgkmcnt(0)
    v_mov_b32 v8, 12444
    s_mov_b32 s9, 0
SPIN_29:
    ds_read_b32 v9, v8
    s_add_u32 s9, s9, 1
    s_cmp_gt_u32 s9, 200000
    s_cbranch_scc1 SPINX_30
    s_waitcnt lgkmcnt(0)
    v_readfirstlane_b32 s10, v9
    s_cmp_ge_u32 s10, 1
    s_cbranch_scc1 SPINX_30
    s_sleep 1
    s_branch SPIN_29
SPINX_30:
    s_waitcnt lgkmcnt(0)
    buffer_load_dwordx4 v[64:67], v4, s[44:47], s12 offen nt
    s_xor_b32 s13, s12, 0x11000
    buffer_load_dwordx4 v[68:71], v4, s[44:47], s13 offen nt
    s_xor_b32 s13, s12, 0x22000
    buffer_load_dwordx4 v[72:75], v4, s[44:47], s13 offen nt
    s_xor_b32 s13, s12, 0x33000
    buffer_load_dwordx4 v[76:79], v4, s[44:47], s13 offen nt
    s_xor_b32 s13, s12, 0x44400
    buffer_load_dwordx4 v[80:83], v4, s[44:47], s13 offen nt
    s_xor_b32 s13, s12, 0x55400
    buffer_load_dwordx4 v[84:87], v4, s[44:47], s13 offen nt
    s_xor_b32 s13, s12, 0x66400
    buffer_load_dwordx4 v[88:91], v4, s[44:47], s13 offen nt
    s_xor_b32 s13, s12, 0x77400
    buffer_load_dwordx4 v[92:95], v4, s[44:47], s13 offen nt
    s_xor_b32 s13, s12, 0x88800
    buffer_load_dwordx4 v[96:99], v4, s[44:47], s13 offen nt
    s_xor_b32 s13, s12, 0x99800
    buffer_load_dwordx4 v[100:103], v4, s[44:47], s13 offen nt
    s_xor_b32 s13, s12, 0xaa800
    buffer_load_dwordx4 v[104:107], v4, s[44:47], s13 offen nt
    s_xor_b32 s13, s12, 0xbb800
    buffer_load_dwordx4 v[108:111], v4, s[44:47], s13 offen nt
    s_xor_b32 s13, s12, 0xccc00
    buffer_load_dwordx4 v[112:115], v4, s[44:47], s13 offen nt
    s_xor_b32 s13, s12, 0xddc00
    buffer_load_dwordx4 v[116:119], v4, s[44:47], s13 offen nt
    s_xor_b32 s13, s12, 0xeec00
    buffer_load_dwordx4 v[120:123], v4, s[44:47], s13 offen nt
    s_xor_b32 s13, s12, 0xffc00
    buffer_load_dwordx4 v[124:127], v4, s[44:47], s13 offen nt
    s_waitcnt vmcnt(14)
    v_perm_b32 v32, v68, v64, s60
    v_perm_b32 v36, v68, v64, s61
    v_perm_b32 v40, v69, v65, s60
    v_perm_b32 v44, v69, v65, s61
    v_perm_b32 v48, v70, v66, s60
    v_perm_b32 v52, v70, v66, s61
    v_perm_b32 v56, v71, v67, s60
    v_perm_b32 v60, v71, v67, s61
    s_waitcnt vmcnt(12)
    v_perm_b32 v33, v76, v72, s60
    v_perm_b32 v37, v76, v72, s61
    v_perm_b32 v41, v77, v73, s60
    v_perm_b32 v45, v77, v73, s61
    v_perm_b32 v49, v78, v74, s60
    v_perm_b32 v53, v78, v74, s61
    v_perm_b32 v57, v79, v75, s60
    v_perm_b32 v61, v79, v75, s61
    s_waitcnt vmcnt(10)
    v_perm_b32 v34, v84, v80, s60
    v_perm_b32 v38, v84, v80, s61
    v_perm_b32 v42, v85, v81, s60
    v_perm_b32 v46, v85, v81, s61
    v_perm_b32 v50, v86, v82, s60
    v_perm_b32 v54, v86, v82, s61
    v_perm_b32 v58, v87, v83, s60
    v_perm_b32 v62, v87, v83, s61
    s_waitcnt vmcnt(8)
    v_perm_b32 v35, v92, v88, s60
    v_perm_b32 v39, v92, v88, s61
    v_perm_b32 v43, v93, v89, s60
    v_perm_b32 v47, v93, v89, s61
    v_perm_b32 v51, v94, v90, s60
    v_perm_b32 v55, v94, v90, s61
    v_perm_b32 v59, v95, v91, s60
    v_perm_b32 v63, v95, v91, s61
    s_waitcnt vmcnt(6)
    v_perm_b32 v64, v100, v96, s60
    v_perm_b32 v68, v100, v96, s61
    v_perm_b32 v72, v101, v97, s60
    v_perm_b32 v76, v101, v97, s61
    v_perm_b32 v80, v102, v98, s60
    v_perm_b32 v84, v102, v98, s61
    v_perm_b32 v88, v103, v99, s60
    v_perm_b32 v92, v103, v99, s61
    s_waitcnt vmcnt(4)
    v_perm_b32 v65, v108, v104, s60
    v_perm_b32 v69, v108, v104, s61
    v_perm_b32 v73, v109, v105, s60
    v_perm_b32 v77, v109, v105, s61
    v_perm_b32 v81, v110, v106, s60
    v_perm_b32 v85, v110, v106, s61
    v_perm_b32 v89, v111, v107, s60
    v_perm_b32 v93, v111, v107, s61
    v_mov_b32 v8, s57
    s_mov_b32 s9, 0
SPR_31:
    ds_read_b32 v9, v8
    ds_read_b128 v[24:27], v13 offset:1024
    ds_read_b128 v[28:31], v13 offset:1280
    s_add_u32 s9, s9, 1
    s_waitcnt lgkmcnt(2)
    v_readfirstlane_b32 s10, v9
    s_cmp_ge_u32 s10, 1
    s_cbranch_scc1 SPRX_32
    s_waitcnt lgkmcnt(0)
    s_cmp_lt_u32 s9, 200000
    s_cbranch_scc1 SPR_31
SPRX_32:
    s_waitcnt lgkmcnt(1)
    v_mfma_f32_16x16x32_bf16 v[128:131], v[24:27], v[32:35], 0
    v_mfma_f32_16x16x32_bf16 v[132:135], v[24:27], v[36:39], 0
    v_mfma_f32_16x16x32_bf16 v[136:139], v[24:27], v[40:43], 0
    v_mfma_f32_16x16x32_bf16 v[140:143], v[24:27], v[44:47], 0
    v_mfma_f32_16x16x32_bf16 v[144:147], v[24:27], v[48:51], 0
    v_mfma_f32_16x16x32_bf16 v[148:151], v[24:27], v[52:55], 0
    v_mfma_f32_16x16x32_bf16 v[152:155], v[24:27], v[56:59], 0
    v_mfma_f32_16x16x32_bf16 v[156:159], v[24:27], v[60:63], 0
    s_waitcnt vmcnt(2)
    v_perm_b32 v66, v116, v112, s60
    v_perm_b32 v70, v116, v112, s61
    v_perm_b32 v74, v117, v113, s60
    v_perm_b32 v78, v117, v113, s61
    v_perm_b32 v82, v118, v114, s60
    v_perm_b32 v86, v118, v114, s61
    v_perm_b32 v90, v119, v115, s60
    v_perm_b32 v94, v119, v115, s61
    s_waitcnt vmcnt(0) lgkmcnt(0)
    v_perm_b32 v67, v124, v120, s60
    v_perm_b32 v71, v124, v120, s61
    v_perm_b32 v75, v125, v121, s60
    v_mfma_f32_16x16x32_bf16 v[128:131], v[28:31], v[64:67], v[128:131]
    v_perm_b32 v79, v125, v121, s61
    v_mfma_f32_16x16x32_bf16 v[132:135], v[28:31], v[68:71], v[132:135]
    v_perm_b32 v83, v126, v122, s60
    v_mfma_f32_16x16x32_bf16 v[136:139], v[28:31], v[72:75], v[136:139]
    v_perm_b32 v87, v126, v122, s61
    v_mfma_f32_16x16x32_bf16 v[140:143], v[28:31], v[76:79], v[140:143]
    v_perm_b32 v91, v127, v123, s60
    v_mfma_f32_16x16x32_bf16 v[144:147], v[28:31], v[80:83], v[144:147]
    v_perm_b32 v95, v127, v123, s61
    v_mfma_f32_16x16x32_bf16 v[148:151], v[28:31], v[84:87], v[148:151]
    v_mfma_f32_16x16x32_bf16 v[152:155], v[28:31], v[88:91], v[152:155]
    v_mfma_f32_16x16x32_bf16 v[156:159], v[28:31], v[92:95], v[156:159]
    v_mov_b32 v96, v128
    v_mov_b32 v97, v132
    v_mov_b32 v98, v136
    v_mov_b32 v99, v140
    ds_write_b128 v19, v[96:99] offset:4096
    v_mov_b32 v100, v144
    v_mov_b32 v101, v148
    v_mov_b32 v102, v152
    v_mov_b32 v103, v156
    ds_write_b128 v19, v[100:103] offset:5120
    s_mov_b64 exec, 1
    ds_add_u32 v21, v20
    s_mov_b64 exec, -1

    s_endpgm
R_B:
    s_lshl_b32 s5, s5, 1
    s_add_u32 s5, s5, s3
    s_sub_u32 s5, s5, 2
    v_lshlrev_b32 v2, 4, v0
    v_lshrrev_b32 v3, 3, v0
    v_and_b32 v4, 7, v0
    v_mul_u32_u24 v5, 28672, v3
    v_lshl_add_u32 v5, v4, 4, v5
    s_lshr_b32 s12, s5, 2
    s_and_b32 s13, s5, 3
    s_and_b32 s14, s4, 1
    s_xor_b32 s15, s14, 1
    s_mul_i32 s15, s15, 3
    s_xor_b32 s14, s14, 1
    s_cmp_eq_u32 s13, s15
    s_cselect_b32 s14, s14, 2
    v_lshrrev_b32 v6, 2, v4
    v_cmp_eq_u32 vcc, s14, v6
    v_mov_b32 v7, 0x7fffff00
    s_nop 0
    v_cndmask_b32 v5, v5, v7, vcc
    s_mul_i32 s14, s4, 7
    s_lshr_b32 s14, s14, 1
    s_add_u32 s14, s14, s13
    s_lshl_b32 s14, s14, 7
    s_mul_i32 s15, s12, 229376
    s_add_u32 s14, s14, s15
    v_lshrrev_b32 v8, 4, v0
    v_and_b32 v9, 15, v0
    v_lshlrev_b32 v10, 13, v8
    v_lshl_add_u32 v10, v9, 4, v10
    v_cmp_eq_u32 vcc, 3, v8
    s_nop 1
    v_cndmask_b32 v11, v10, v7, vcc
    s_lshl_b32 s56, s4, 3
    s_add_u32 s56, s56, s12
    s_mul_i32 s57, s56, 28672
    s_lshl_b32 s15, s13, 8
    s_add_u32 s57, s57, s15
    s_add_u32 s92, s57, 4096
    v_min_u32 v12, 6, v4
    v_lshl_add_u32 v13, v12, 2, v8
    v_lshlrev_b32 v13, 1, v13
    s_mul_i32 s15, s56, 56
    s_lshl_b32 s62, s3, 10
    v_add_u32 v7, s62, v2
    s_and_b32 s63, s3, 1
    s_lshl_b32 s63, s63, 6
    s_waitcnt lgkmcnt(0)

    s_mov_b32 s44, s16
    s_mov_b32 s45, s17
    s_mov_b32 s46, 0x400
    s_mov_b32 s47, 0x20000
    s_mov_b32 s48, s28
    s_mov_b32 s49, s29
    s_mov_b32 s50, 0x1c0000
    s_mov_b32 s51, 0x20000
    s_mov_b32 s52, s32
    s_mov_b32 s53, s33
    s_mov_b32 s54, 0x1c0000
    s_mov_b32 s55, 0x20000
    s_mov_b32 s42, 0x10000000
    s_mov_b32 s43, 0x20000
    s_mov_b32 s60, 0x05040100
    s_mov_b32 s61, 0x07060302
    v_mov_b32 v15, 0xfffff000

    s_load_dword s6, s[40:41], 0
    s_waitcnt lgkmcnt(0)
    s_add_u32 s8, s6, 1
    s_and_b32 s7, s8, 0xfff
    s_and_b32 s94, s8, 0x3ff
    v_mov_b32 v56, 12440
    v_mov_b32 v57, 1
    s_mov_b64 exec, 1
    ds_add_u32 v56, v57
    s_mov_b64 exec, -1
    v_and_b32 v56, 1, v0
    v_cmp_eq_u32 vcc, 1, v56
    v_mov_b32 v56, 0x0c0c0100
    v_mov_b32 v57, 0x01000c0c
    v_cndmask_b32 v57, v56, v57, vcc
    v_mov_b32 v56, 0x0c0c0302
    v_mov_b32 v58, 0x03020c0c
    v_cndmask_b32 v58, v56, v58, vcc
    v_bfe_u32 v56, v0, 1, 2
    v_mov_b32 v59, 0x0c0c0c0c
    v_cmp_eq_u32 vcc, 0, v56
    s_nop 1
    v_cndmask_b32 v36, v59, v57, vcc
    v_cndmask_b32 v37, v59, v58, vcc
    v_cmp_eq_u32 vcc, 1, v56
    s_nop 1
    v_cndmask_b32 v38, v59, v57, vcc
    v_cndmask_b32 v39, v59, v58, vcc
    v_cmp_eq_u32 vcc, 2, v56
    s_nop 1
    v_cndmask_b32 v40, v59, v57, vcc
    v_cndmask_b32 v41, v59, v58, vcc
    v_cmp_eq_u32 vcc, 3, v56
    s_nop 1
    v_cndmask_b32 v42, v59, v57, vcc
    v_cndmask_b32 v43, v59, v58, vcc
    v_mov_b32 v15, 0xfffff000
    v_mov_b32 v56, 12444
    s_mov_b32 s9, 0
SPIN_33:
    ds_read_b32 v57, v56
    s_add_u32 s9, s9, 1
    s_cmp_gt_u32 s9, 200000
    s_cbranch_scc1 SPINX_34
    s_waitcnt lgkmcnt(0)
    v_readfirstlane_b32 s10, v57
    s_cmp_ge_u32 s10, 2
    s_cbranch_scc1 SPINX_34
    s_sleep 1
    s_branch SPIN_33
SPINX_34:
    s_waitcnt lgkmcnt(0)
    buffer_load_dwordx4 v[16:19], v2, s[44:47], 0 offen
    s_mov_b32 s44, s30
    s_mov_b32 s45, s31
    s_mov_b32 s46, 0xe00
    s_mov_b32 s47, 0x20000
    buffer_load_ushort v14, v13, s[44:47], s15 offen
    v_add_u32 v13, s63, v13
    buffer_load_dwordx4 v[64:67], v5, s[48:51], s14 offen nt
    s_add_u32 s14, s14, 3584
    buffer_load_dwordx4 v[68:71], v5, s[48:51], s14 offen nt
    s_add_u32 s14, s14, 3584
    buffer_load_dwordx4 v[72:75], v5, s[48:51], s14 offen nt
    s_add_u32 s14, s14, 3584
    buffer_load_dwordx4 v[76:79], v5, s[48:51], s14 offen nt
    s_add_u32 s14, s14, 3584
    buffer_load_dwordx4 v[80:83], v5, s[48:51], s14 offen nt
    s_add_u32 s14, s14, 3584
    buffer_load_dwordx4 v[84:87], v5, s[48:51], s14 offen nt
    s_add_u32 s14, s14, 3584
    buffer_load_dwordx4 v[88:91], v5, s[48:51], s14 offen nt
    s_add_u32 s14, s14, 3584
    buffer_load_dwordx4 v[92:95], v5, s[48:51], s14 offen nt
    v_mov_b32 v56, 12464
    v_mov_b32 v57, 1
    s_mov_b64 exec, 1
    ds_add_u32 v56, v57
    s_mov_b64 exec, -1

    s_waitcnt vmcnt(8)
    v_lshlrev_b32 v20, 16, v16
    v_and_b32 v21, 0xffff0000, v16
    v_lshlrev_b32 v22, 16, v17
    v_and_b32 v23, 0xffff0000, v17
    v_lshlrev_b32 v24, 16, v18
    v_and_b32 v25, 0xffff0000, v18
    v_lshlrev_b32 v26, 16, v19
    v_and_b32 v27, 0xffff0000, v19
    v_readlane_b32 s11, v20, 0
    s_nop 1
    v_subrev_f32 v56, s11, v20
    v_mul_f32 v57, v56, v56
    v_subrev_f32 v58, s11, v21
    v_add_f32 v56, v56, v58
    v_fmac_f32 v57, v58, v58
    v_subrev_f32 v58, s11, v22
    v_add_f32 v56, v56, v58
    v_fmac_f32 v57, v58, v58
    v_subrev_f32 v58, s11, v23
    v_add_f32 v56, v56, v58
    v_fmac_f32 v57, v58, v58
    v_subrev_f32 v58, s11, v24
    v_add_f32 v56, v56, v58
    v_fmac_f32 v57, v58, v58
    v_subrev_f32 v58, s11, v25
    v_add_f32 v56, v56, v58
    v_fmac_f32 v57, v58, v58
    v_subrev_f32 v58, s11, v26
    v_add_f32 v56, v56, v58
    v_fmac_f32 v57, v58, v58
    v_subrev_f32 v58, s11, v27
    v_add_f32 v56, v56, v58
    v_fmac_f32 v57, v58, v58
    s_nop 0
    v_add_f32_dpp v56, v56, v56 row_ror:1 row_mask:0xf bank_mask:0xf
    v_add_f32_dpp v57, v57, v57 row_ror:1 row_mask:0xf bank_mask:0xf
    s_nop 0
    v_add_f32_dpp v56, v56, v56 row_ror:2 row_mask:0xf bank_mask:0xf
    v_add_f32_dpp v57, v57, v57 row_ror:2 row_mask:0xf bank_mask:0xf
    s_nop 0
    v_add_f32_dpp v56, v56, v56 row_ror:4 row_mask:0xf bank_mask:0xf
    v_add_f32_dpp v57, v57, v57 row_ror:4 row_mask:0xf bank_mask:0xf
    s_nop 0
    v_add_f32_dpp v56, v56, v56 row_ror:8 row_mask:0xf bank_mask:0xf
    v_add_f32_dpp v57, v57, v57 row_ror:8 row_mask:0xf bank_mask:0xf
    s_nop 0
    v_add_f32_dpp v56, v56, v56 row_bcast:15 row_mask:0xa bank_mask:0xf
    v_add_f32_dpp v57, v57, v57 row_bcast:15 row_mask:0xa bank_mask:0xf
    s_nop 0
    v_add_f32_dpp v56, v56, v56 row_bcast:31 row_mask:0xc bank_mask:0xf
    v_add_f32_dpp v57, v57, v57 row_bcast:31 row_mask:0xc bank_mask:0xf
    v_readlane_b32 s58, v56, 63
    v_readlane_b32 s59, v57, 63
    v_mov_b32 v58, 0x3b000000
    v_mul_f32 v56, s58, v58
    v_mul_f32 v57, s59, v58
    v_fma_f32 v57, -v56, v56, v57
    v_add_f32 v56, s11, v56
    v_max_f32 v57, 0, v57
    v_cvt_pk_bf16_f32 v57, v56, v57
    v_lshlrev_b32 v56, 16, v57
    v_and_b32 v57, 0xffff0000, v57
    v_add_f32 v57, 0x3727c5ac, v57
    v_sub_f32 v20, v20, v56
    v_sub_f32 v21, v21, v56
    v_sub_f32 v22, v22, v56
    v_sub_f32 v23, v23, v56
    v_cvt_pk_bf16_f32 v57, v57, v57
    v_lshlrev_b32 v57, 16, v57
    v_sub_f32 v24, v24, v56
    v_sub_f32 v25, v25, v56
    v_sub_f32 v26, v26, v56
    v_sub_f32 v27, v27, v56
    v_sqrt_f32 v57, v57
    v_cvt_pk_bf16_f32 v16, v20, v21
    v_cvt_pk_bf16_f32 v17, v22, v23
    v_cvt_pk_bf16_f32 v18, v24, v25
    v_cvt_pk_bf16_f32 v19, v26, v27
    v_cvt_pk_bf16_f32 v57, v57, v57
    v_lshlrev_b32 v57, 16, v57
    v_rcp_f32 v57, v57
    v_lshlrev_b32 v20, 16, v16
    v_and_b32 v21, 0xffff0000, v16
    v_lshlrev_b32 v22, 16, v17
    v_and_b32 v23, 0xffff0000, v17
    v_lshlrev_b32 v24, 16, v18
    v_and_b32 v25, 0xffff0000, v18
    v_lshlrev_b32 v26, 16, v19
    v_and_b32 v27, 0xffff0000, v19
    v_mul_f32 v20, v20, v57
    v_mul_f32 v21, v21, v57
    v_mul_f32 v22, v22, v57
    v_mul_f32 v23, v23, v57
    v_mul_f32 v24, v24, v57
    v_mul_f32 v25, v25, v57
    v_mul_f32 v26, v26, v57
    v_mul_f32 v27, v27, v57
    v_cvt_pk_bf16_f32 v16, v20, v21
    v_cvt_pk_bf16_f32 v17, v22, v23
    v_cvt_pk_bf16_f32 v18, v24, v25
    v_cvt_pk_bf16_f32 v19, v26, v27
    ds_write_b128 v7, v[16:19]
    s_lshl_b32 s15, s12, 7
    s_add_u32 s15, s15, s62
    v_lshl_add_u32 v6, v3, 4, s15
    ds_read_b128 v[28:31], v6
    v_lshrrev_b32 v6, 4, v0
    v_lshlrev_b32 v6, 4, v6
    v_lshl_add_u32 v6, v4, 5, v6
    s_lshl_b32 s14, s56, 10
    s_lshl_b32 s15, s13, 8
    s_add_u32 s14, s14, s15
    s_add_u32 s14, s14, 0x20000
    s_add_u32 s15, s14, 0x90000

    s_waitcnt lgkmcnt(0)
    v_perm_b32 v44, v28, v28, v36
    v_perm_b32 v45, v28, v28, v38
    v_perm_b32 v46, v28, v28, v40
    v_perm_b32 v47, v28, v28, v42
    v_perm_b32 v48, v28, v28, v37
    v_perm_b32 v49, v28, v28, v39
    v_perm_b32 v50, v28, v28, v41
    v_perm_b32 v51, v28, v28, v43
    s_waitcnt vmcnt(7)
    v_mfma_f32_16x16x32_bf16 v[52:55], v[44:47], v[64:67], 0
    v_perm_b32 v44, v29, v29, v36
    v_perm_b32 v45, v29, v29, v38
    v_perm_b32 v46, v29, v29, v40
    v_perm_b32 v47, v29, v29, v42
    s_waitcnt vmcnt(6)
    v_mfma_f32_16x16x32_bf16 v[52:55], v[48:51], v[68:71], v[52:55]
    v_perm_b32 v48, v29, v29, v37
    v_perm_b32 v49, v29, v29, v39
    v_perm_b32 v50, v29, v29, v41
    v_perm_b32 v51, v29, v29, v43
    s_waitcnt vmcnt(5)
    v_mfma_f32_16x16x32_bf16 v[52:55], v[44:47], v[72:75], v[52:55]
    v_perm_b32 v44, v30, v30, v36
    v_perm_b32 v45, v30, v30, v38
    v_perm_b32 v46, v30, v30, v40
    v_perm_b32 v47, v30, v30, v42
    s_waitcnt vmcnt(4)
    v_mfma_f32_16x16x32_bf16 v[52:55], v[48:51], v[76:79], v[52:55]
    v_perm_b32 v48, v30, v30, v37
    v_perm_b32 v49, v30, v30, v39
    v_perm_b32 v50, v30, v30, v41
    v_perm_b32 v51, v30, v30, v43
    s_waitcnt vmcnt(3)
    v_mfma_f32_16x16x32_bf16 v[52:55], v[44:47], v[80:83], v[52:55]
    v_perm_b32 v44, v31, v31, v36
    v_perm_b32 v45, v31, v31, v38
    v_perm_b32 v46, v31, v31, v40
    v_perm_b32 v47, v31, v31, v42
    s_waitcnt vmcnt(2)
    v_mfma_f32_16x16x32_bf16 v[52:55], v[48:51], v[84:87], v[52:55]
    v_perm_b32 v48, v31, v31, v37
    v_perm_b32 v49, v31, v31, v39
    v_perm_b32 v50, v31, v31, v41
    v_perm_b32 v51, v31, v31, v43
    s_waitcnt vmcnt(1)
    v_mfma_f32_16x16x32_bf16 v[52:55], v[44:47], v[88:91], v[52:55]
    s_waitcnt vmcnt(0)
    v_mfma_f32_16x16x32_bf16 v[52:55], v[48:51], v[92:95], v[52:55]
    s_nop 7
    v_mov_b32 v56, v52
    v_mov_b32 v57, v53
    v_mov_b32 v58, v54
    v_mov_b32 v59, v55
    v_permlane32_swap_b32 v52, v56
    v_permlane32_swap_b32 v53, v57
    v_permlane32_swap_b32 v54, v58
    v_permlane32_swap_b32 v55, v59
    v_add_f32_dpp v52, v56, v52 row_ror:8 row_mask:0xf bank_mask:0xf
    v_add_f32_dpp v53, v57, v53 row_ror:8 row_mask:0xf bank_mask:0xf
    v_add_f32_dpp v54, v58, v54 row_ror:8 row_mask:0xf bank_mask:0xf
    v_add_f32_dpp v55, v59, v55 row_ror:8 row_mask:0xf bank_mask:0xf
    v_mov_b32 v56, 0xfffffc00
    v_add_u32 v52, 0x200, v52
    v_add_u32 v53, 0x200, v53
    v_add_u32 v54, 0x200, v54
    v_add_u32 v55, 0x200, v55
    v_and_or_b32 v52, v52, v56, s94
    v_and_or_b32 v53, v53, v56, s94
    v_and_or_b32 v54, v54, v56, s94
    v_and_or_b32 v55, v55, v56, s94
    s_mov_b64 exec, 0x00ff00ff
    buffer_store_dwordx4 v[52:55], v6, s[40:43], s14 offen offset:0
    buffer_store_dwordx4 v[52:55], v6, s[40:43], s15 offen offset:0 sc1
    s_mov_b64 exec, -1
    v_mov_b32 v56, 12444
    v_mov_b32 v57, 1
    s_mov_b64 exec, 1
    ds_add_u32 v56, v57
    s_mov_b64 exec, -1
    buffer_load_dwordx4 v[96:99], v10, s[52:55], s57 offen offset:0 nt
    buffer_load_dwordx4 v[100:103], v10, s[52:55], s57 offen offset:1024 nt
    buffer_load_dwordx4 v[104:107], v10, s[52:55], s57 offen offset:2048 nt
    buffer_load_dwordx4 v[108:111], v10, s[52:55], s57 offen offset:3072 nt
    buffer_load_dwordx4 v[112:115], v11, s[52:55], s92 offen offset:0 nt
    buffer_load_dwordx4 v[116:119], v11, s[52:55], s92 offen offset:1024 nt
    buffer_load_dwordx4 v[120:123], v11, s[52:55], s92 offen offset:2048 nt
    buffer_load_dwordx4 v[124:127], v11, s[52:55], s92 offen offset:3072 nt
    v_lshlrev_b32 v6, 10, v3
    v_lshl_add_u32 v6, v12, 4, v6
    s_lshl_b32 s14, s4, 13
    s_and_b32 s15, s4, 1
    s_lshl_b32 s15, s15, 7
    s_add_u32 s14, s14, s15
    s_mul_i32 s15, s12, 112
    s_add_u32 s14, s14, s15
    s_add_u32 s14, s14, 0x20000

    s_waitcnt vmcnt(6)
    v_mov_b32 v56, 12444
    v_mov_b32 v57, 1
    s_mov_b64 exec, 1
    ds_add_u32 v56, v57
    s_mov_b64 exec, -1
    v_perm_b32 v64, v100, v96, s60
    v_perm_b32 v68, v100, v96, s61
    v_perm_b32 v72, v101, v97, s60
    v_perm_b32 v76, v101, v97, s61
    v_perm_b32 v80, v102, v98, s60
    v_perm_b32 v84, v102, v98, s61
    v_perm_b32 v88, v103, v99, s60
    v_perm_b32 v92, v103, v99, s61
    s_waitcnt vmcnt(4)
    v_perm_b32 v65, v108, v104, s60
    v_perm_b32 v69, v108, v104, s61
    v_perm_b32 v73, v109, v105, s60
    v_perm_b32 v77, v109, v105, s61
    v_perm_b32 v81, v110, v106, s60
    v_perm_b32 v85, v110, v106, s61
    v_perm_b32 v89, v111, v107, s60
    v_perm_b32 v93, v111, v107, s61
    s_waitcnt vmcnt(2)
    v_perm_b32 v66, v116, v112, s60
    v_perm_b32 v70, v116, v112, s61
    v_perm_b32 v74, v117, v113, s60
    v_perm_b32 v78, v117, v113, s61
    v_perm_b32 v82, v118, v114, s60
    v_perm_b32 v86, v118, v114, s61
    v_perm_b32 v90, v119, v115, s60
    v_perm_b32 v94, v119, v115, s61
    s_waitcnt vmcnt(0)
    v_perm_b32 v67, v124, v120, s60
    v_perm_b32 v71, v124, v120, s61
    v_perm_b32 v75, v125, v121, s60
    v_perm_b32 v79, v125, v121, s61
    v_perm_b32 v83, v126, v122, s60
    v_perm_b32 v87, v126, v122, s61
    v_perm_b32 v91, v127, v123, s60
    v_perm_b32 v95, v127, v123, s61
    s_mov_b32 s9, 0
POLL_35:
    s_and_b32 s10, s9, 31
    s_cmp_eq_u32 s10, 31
    s_cselect_b32 s10, 0x90000, 0
    v_add_u32 v5, s10, v6
    buffer_load_dwordx4 v[20:23], v5, s[40:43], s14 offen sc1
    s_add_u32 s9, s9, 1
    s_waitcnt vmcnt(0)
    v_xor_b32 v20, s94, v20
    v_xor_b32 v21, s94, v21
    v_xor_b32 v22, s94, v22
    v_xor_b32 v23, s94, v23
    v_or3_b32 v7, v20, v21, v22
    v_or_b32 v7, v7, v23
    v_and_b32 v7, 0x3ff, v7
    v_cmp_ne_u32 vcc, 0, v7
    s_cbranch_vccz POLLX_36
    s_mov_b64 exec, vcc
    s_cmp_gt_u32 s9, 200000
    s_cbranch_scc1 POLLX_36
    s_sleep 1
    s_branch POLL_35
POLLX_36:
    s_mov_b64 exec, -1
    v_permlane32_swap_b32 v20, v22
    v_permlane32_swap_b32 v21, v23
    v_add_f32 v20, v20, v22
    v_add_f32 v21, v21, v23
    s_nop 1
    v_permlane16_swap_b32 v20, v21
    v_add_f32 v20, v20, v21
    s_nop 1
    v_add_f32_dpp v20, v20, v20 row_ror:8 row_mask:0xf bank_mask:0xf
    v_lshlrev_b32 v14, 16, v14
    v_cvt_pk_bf16_f32 v20, v20, v20
    v_lshlrev_b32 v20, 16, v20
    v_add_f32 v20, v20, v14
    v_cvt_pk_bf16_f32 v20, v20, v20
    v_lshlrev_b32 v20, 16, v20
    v_mul_f32 v21, v20, v20
    v_mov_b32 v22, 0xc0135761
    v_mov_b32 v23, 0xbdd2d3e8
    v_fma_f32 v21, v21, v23, v22
    v_mul_f32 v21, v21, v20
    v_exp_f32 v21, v21
    s_nop 0
    v_add_f32 v21, 1.0, v21
    v_rcp_f32 v21, v21
    s_nop 0
    v_mul_f32 v20, v20, v21
    v_cvt_pk_bf16_f32 v20, v20, v20
    ds_write_b16 v13, v20 offset:12288
    v_lshl_add_u32 v6, v8, 4, s63
    ds_read_b128 v[24:27], v6 offset:12288
    v_lshlrev_b32 v6, 4, v0
    s_lshl_b32 s14, s56, 11
    s_lshl_b32 s15, s13, 9
    s_add_u32 s14, s14, s15
    s_add_u32 s14, s14, 0x180000
    s_waitcnt lgkmcnt(0)

    v_mfma_f32_16x16x32_bf16 v[96:99], v[24:27], v[64:67], 0
    v_mfma_f32_16x16x32_bf16 v[100:103], v[24:27], v[68:71], 0
    v_mfma_f32_16x16x32_bf16 v[104:107], v[24:27], v[72:75], 0
    v_mfma_f32_16x16x32_bf16 v[108:111], v[24:27], v[76:79], 0
    v_mfma_f32_16x16x32_bf16 v[112:115], v[24:27], v[80:83], 0
    v_mfma_f32_16x16x32_bf16 v[116:119], v[24:27], v[84:87], 0
    v_mfma_f32_16x16x32_bf16 v[120:123], v[24:27], v[88:91], 0
    v_mfma_f32_16x16x32_bf16 v[124:127], v[24:27], v[92:95], 0
    s_nop 0
    v_and_or_b32 v28, v96, v15, s7
    v_and_or_b32 v29, v100, v15, s7
    v_and_or_b32 v30, v104, v15, s7
    v_and_or_b32 v31, v108, v15, s7
    v_and_or_b32 v32, v112, v15, s7
    v_and_or_b32 v33, v116, v15, s7
    v_and_or_b32 v34, v120, v15, s7
    v_and_or_b32 v35, v124, v15, s7
    s_mov_b64 exec, 0xffff
    buffer_store_dwordx4 v[28:31], v6, s[40:43], s14 offen sc1
    buffer_store_dwordx4 v[32:35], v6, s[40:43], s14 offen offset:256 sc1
    s_mov_b64 exec, -1
    s_endpgm
R_WO:
    s_sub_u32 s13, s3, 4
    s_lshl_b32 s62, s4, 19
    s_lshl_b32 s15, s5, 13
    s_add_u32 s62, s62, s15
    s_lshl_b32 s15, s13, 8
    s_add_u32 s62, s62, s15
    s_add_u32 s63, s62, 4096
    v_lshrrev_b32 v8, 4, v0
    v_and_b32 v9, 15, v0
    v_lshlrev_b32 v10, 17, v8
    v_lshl_add_u32 v10, v9, 4, v10
    v_bfe_u32 v11, v0, 1, 3
    v_and_b32 v12, 1, v0
    v_lshlrev_b32 v13, 9, v11
    v_lshl_add_u32 v13, v12, 6, v13
    v_lshl_add_u32 v13, v8, 4, v13
    v_lshlrev_b32 v14, 6, v11
    v_lshl_add_u32 v14, v8, 4, v14
    v_mov_b32 v15, 0xfffff000
    s_lshl_b32 s14, s4, 4
    s_add_u32 s14, s14, s5
    s_lshl_b32 s14, s14, 9
    s_add_u32 s14, s14, 0x80000
    s_add_u32 s54, s14, 0x10000
    s_lshr_b32 s52, s5, 2
    s_lshl_b32 s52, s52, 16
    s_and_b32 s15, s5, 3
    s_lshl_b32 s15, s15, 7
    s_add_u32 s52, s52, s15
    s_lshl_b32 s15, s4, 13
    s_add_u32 s52, s52, s15
    s_add_u32 s52, s52, 0x40000
    s_add_u32 s53, s52, 0x1000
    s_lshl_b32 s58, s4, 4
    s_add_u32 s58, s58, s5
    s_lshl_b32 s58, s58, 11
    s_lshl_b32 s59, s13, 9
    s_add_u32 s58, s58, s59
    s_add_u32 s58, s58, 0x140000
    v_lshlrev_b32 v6, 4, v0
    s_waitcnt lgkmcnt(0)

    s_mov_b32 s48, s24
    s_mov_b32 s49, s25
    s_mov_b32 s50, 0x400000
    s_mov_b32 s51, 0x20000
    s_mov_b32 s42, 0x10000000
    s_mov_b32 s43, 0x20000
    s_mov_b32 s60, 0x05040100
    s_mov_b32 s61, 0x07060302
    v_mov_b32 v15, 0xfffff000

    s_load_dword s6, s[40:41], 0
    s_waitcnt lgkmcnt(0)
    s_add_u32 s8, s6, 1
    s_and_b32 s7, s8, 0xfff
    s_and_b32 s94, s8, 0x3ff
    v_mov_b32 v2, 12440
    v_mov_b32 v3, 1
    s_mov_b64 exec, 1
    ds_add_u32 v2, v3
    s_mov_b64 exec, -1
    s_cmp_lt_u32 s13, 2
    s_cselect_b32 s59, 64, 64
    v_mov_b32 v2, 12444
    s_mov_b32 s9, 0
SPIN_37:
    ds_read_b32 v3, v2
    s_add_u32 s9, s9, 1
    s_cmp_gt_u32 s9, 200000
    s_cbranch_scc1 SPINX_38
    s_waitcnt lgkmcnt(0)
    v_readfirstlane_b32 s10, v3
    s_cmp_ge_u32 s10, s59
    s_cbranch_scc1 SPINX_38
    s_sleep 2
    s_branch SPIN_37
SPINX_38:
    s_waitcnt lgkmcnt(0)
    buffer_load_dwordx4 v[96:99], v10, s[48:51], s62 offen offset:0 nt
    buffer_load_dwordx4 v[100:103], v10, s[48:51], s62 offen offset:1024 nt
    buffer_load_dwordx4 v[104:107], v10, s[48:51], s62 offen offset:2048 nt
    buffer_load_dwordx4 v[108:111], v10, s[48:51], s62 offen offset:3072 nt
    buffer_load_dwordx4 v[112:115], v10, s[48:51], s63 offen offset:0 nt
    buffer_load_dwordx4 v[116:119], v10, s[48:51], s63 offen offset:1024 nt
    buffer_load_dwordx4 v[120:123], v10, s[48:51], s63 offen offset:2048 nt
    buffer_load_dwordx4 v[124:127], v10, s[48:51], s63 offen offset:3072 nt
    s_waitcnt vmcnt(6)
    v_mov_b32 v2, 12444
    v_mov_b32 v3, 1
    s_mov_b64 exec, 1
    ds_add_u32 v2, v3
    s_mov_b64 exec, -1
    v_perm_b32 v64, v100, v96, s60
    v_perm_b32 v68, v100, v96, s61
    v_perm_b32 v72, v101, v97, s60
    v_perm_b32 v76, v101, v97, s61
    v_perm_b32 v80, v102, v98, s60
    v_perm_b32 v84, v102, v98, s61
    v_perm_b32 v88, v103, v99, s60
    v_perm_b32 v92, v103, v99, s61
    s_waitcnt vmcnt(4)
    v_perm_b32 v65, v108, v104, s60
    v_perm_b32 v69, v108, v104, s61
    v_perm_b32 v73, v109, v105, s60
    v_perm_b32 v77, v109, v105, s61
    v_perm_b32 v81, v110, v106, s60
    v_perm_b32 v85, v110, v106, s61
    v_perm_b32 v89, v111, v107, s60
    v_perm_b32 v93, v111, v107, s61
    s_waitcnt vmcnt(2)
    buffer_load_dwordx4 v[28:31], v14, s[40:43], s14 offen sc1
    buffer_load_dwordx4 v[32:35], v14, s[40:43], s54 offen sc1
    buffer_load_dwordx4 v[20:23], v13, s[40:43], s52 offen sc1
    buffer_load_dwordx4 v[24:27], v13, s[40:43], s53 offen sc1
    v_perm_b32 v66, v116, v112, s60
    v_perm_b32 v70, v116, v112, s61
    v_perm_b32 v74, v117, v113, s60
    v_perm_b32 v78, v117, v113, s61
    v_perm_b32 v82, v118, v114, s60
    v_perm_b32 v86, v118, v114, s61
    v_perm_b32 v90, v119, v115, s60
    v_perm_b32 v94, v119, v115, s61
    s_waitcnt vmcnt(4)
    v_perm_b32 v67, v124, v120, s60
    v_perm_b32 v71, v124, v120, s61
    v_perm_b32 v75, v125, v121, s60
    v_perm_b32 v79, v125, v121, s61
    v_perm_b32 v83, v126, v122, s60
    v_perm_b32 v87, v126, v122, s61
    v_perm_b32 v91, v127, v123, s60
    v_perm_b32 v95, v127, v123, s61
    s_waitcnt vmcnt(2)
    v_xor_b32 v28, s7, v28
    v_xor_b32 v29, s7, v29
    v_xor_b32 v30, s7, v30
    v_xor_b32 v31, s7, v31
    v_xor_b32 v32, s7, v32
    v_xor_b32 v33, s7, v33
    v_xor_b32 v34, s7, v34
    v_xor_b32 v35, s7, v35
    v_or3_b32 v2, v28, v29, v30
    v_or3_b32 v2, v2, v31, v32
    v_or3_b32 v2, v2, v33, v34
    v_or_b32 v2, v2, v35
    v_and_b32 v2, 0xfff, v2
    v_cmp_ne_u32 vcc, 0, v2
    s_cbranch_vccz WO_mlok
    s_mov_b64 exec, vcc
    s_mov_b32 s9, 0
POLL_39:
    s_and_b32 s10, s9, 31
    s_cmp_eq_u32 s10, 31
    s_cselect_b32 s10, 0x90000, 0
    v_add_u32 v4, s10, v14
    buffer_load_dwordx4 v[28:31], v4, s[40:43], s14 offen sc1
    buffer_load_dwordx4 v[32:35], v4, s[40:43], s54 offen sc1
    s_add_u32 s9, s9, 1
    s_waitcnt vmcnt(0)
    v_xor_b32 v28, s7, v28
    v_xor_b32 v29, s7, v29
    v_xor_b32 v30, s7, v30
    v_xor_b32 v31, s7, v31
    v_xor_b32 v32, s7, v32
    v_xor_b32 v33, s7, v33
    v_xor_b32 v34, s7, v34
    v_xor_b32 v35, s7, v35
    v_or3_b32 v2, v28, v29, v30
    v_or3_b32 v2, v2, v31, v32
    v_or3_b32 v2, v2, v33, v34
    v_or_b32 v2, v2, v35
    v_and_b32 v2, 0xfff, v2
    v_cmp_ne_u32 vcc, 0, v2
    s_cbranch_vccz POLLX_40
    s_mov_b64 exec, vcc
    s_cmp_gt_u32 s9, 200000
    s_cbranch_scc1 POLLX_40
    s_branch POLL_39
POLLX_40:
    s_mov_b64 exec, -1
    buffer_load_dwordx4 v[20:23], v13, s[40:43], s52 offen sc1
    buffer_load_dwordx4 v[24:27], v13, s[40:43], s53 offen sc1
WO_mlok:
    v_max_f32 v48, v28, v32
    s_nop 1
    v_max_f32_dpp v48, v48, v48 quad_perm:[2,3,0,1] row_mask:0xf bank_mask:0xf
    s_nop 1
    v_max_f32_dpp v48, v48, v48 row_ror:4 row_mask:0xf bank_mask:0xf
    s_nop 1
    v_max_f32_dpp v48, v48, v48 row_ror:8 row_mask:0xf bank_mask:0xf

    v_sub_f32 v52, v28, v48
    v_sub_f32 v53, v32, v48
    v_mul_f32 v52, 0x3fb8aa3b, v52
    v_mul_f32 v53, 0x3fb8aa3b, v53
    v_exp_f32 v52, v52
    v_exp_f32 v53, v53
    v_mul_f32 v49, v52, v29
    v_fmac_f32 v49, v53, v33
    s_nop 1
    v_add_f32_dpp v49, v49, v49 quad_perm:[2,3,0,1] row_mask:0xf bank_mask:0xf
    s_nop 1
    v_add_f32_dpp v49, v49, v49 row_ror:4 row_mask:0xf bank_mask:0xf
    s_nop 1
    v_add_f32_dpp v49, v49, v49 row_ror:8 row_mask:0xf bank_mask:0xf
    v_rcp_f32 v49, v49
    s_nop 0
    v_mul_f32 v52, v52, v49
    v_mul_f32 v53, v53, v49
    s_waitcnt vmcnt(0)
    v_xor_b32 v20, s7, v20
    v_xor_b32 v21, s7, v21
    v_xor_b32 v22, s7, v22
    v_xor_b32 v23, s7, v23
    v_xor_b32 v24, s7, v24
    v_xor_b32 v25, s7, v25
    v_xor_b32 v26, s7, v26
    v_xor_b32 v27, s7, v27
    v_or3_b32 v2, v20, v21, v22
    v_or3_b32 v2, v2, v23, v24
    v_or3_b32 v2, v2, v25, v26
    v_or_b32 v2, v2, v27
    v_and_b32 v2, 0xfff, v2
    v_cmp_ne_u32 vcc, 0, v2
    s_cbranch_vccz WO_ok
    s_mov_b64 exec, vcc
    s_mov_b32 s9, 0
POLL_41:
    s_and_b32 s10, s9, 31
    s_cmp_eq_u32 s10, 31
    s_cselect_b32 s10, 0x90000, 0
    v_add_u32 v5, s10, v13
    buffer_load_dwordx4 v[20:23], v5, s[40:43], s52 offen sc1
    buffer_load_dwordx4 v[24:27], v5, s[40:43], s53 offen sc1
    s_add_u32 s9, s9, 1
    s_waitcnt vmcnt(0)
    v_xor_b32 v20, s7, v20
    v_xor_b32 v21, s7, v21
    v_xor_b32 v22, s7, v22
    v_xor_b32 v23, s7, v23
    v_xor_b32 v24, s7, v24
    v_xor_b32 v25, s7, v25
    v_xor_b32 v26, s7, v26
    v_xor_b32 v27, s7, v27
    v_or3_b32 v2, v20, v21, v22
    v_or3_b32 v2, v2, v23, v24
    v_or3_b32 v2, v2, v25, v26
    v_or_b32 v2, v2, v27
    v_and_b32 v2, 0xfff, v2
    v_cmp_ne_u32 vcc, 0, v2
    s_cbranch_vccz POLLX_42
    s_mov_b64 exec, vcc
    s_cmp_gt_u32 s9, 200000
    s_cbranch_scc1 POLLX_42
    s_branch POLL_41
POLLX_42:
    s_mov_b64 exec, -1
WO_ok:
    v_mul_f32 v56, v52, v20
    v_mul_f32 v57, v52, v21
    v_mul_f32 v58, v52, v22
    v_mul_f32 v59, v52, v23
    v_fmac_f32 v56, v53, v24
    v_fmac_f32 v57, v53, v25
    v_fmac_f32 v58, v53, v26
    v_fmac_f32 v59, v53, v27
    v_add_f32_dpp v56, v56, v56 quad_perm:[2,3,0,1] row_mask:0xf bank_mask:0xf
    v_add_f32_dpp v57, v57, v57 quad_perm:[2,3,0,1] row_mask:0xf bank_mask:0xf
    v_add_f32_dpp v58, v58, v58 quad_perm:[2,3,0,1] row_mask:0xf bank_mask:0xf
    v_add_f32_dpp v59, v59, v59 quad_perm:[2,3,0,1] row_mask:0xf bank_mask:0xf
    v_add_f32_dpp v56, v56, v56 row_ror:4 row_mask:0xf bank_mask:0xf
    v_add_f32_dpp v57, v57, v57 row_ror:4 row_mask:0xf bank_mask:0xf
    v_add_f32_dpp v58, v58, v58 row_ror:4 row_mask:0xf bank_mask:0xf
    v_add_f32_dpp v59, v59, v59 row_ror:4 row_mask:0xf bank_mask:0xf
    v_add_f32_dpp v56, v56, v56 row_ror:8 row_mask:0xf bank_mask:0xf
    v_add_f32_dpp v57, v57, v57 row_ror:8 row_mask:0xf bank_mask:0xf
    v_add_f32_dpp v58, v58, v58 row_ror:8 row_mask:0xf bank_mask:0xf
    v_add_f32_dpp v59, v59, v59 row_ror:8 row_mask:0xf bank_mask:0xf
    v_cvt_pk_bf16_f32 v60, v56, v57
    v_cvt_pk_bf16_f32 v61, v58, v59
    s_nop 0
    v_mov_b32_dpp v62, v60 quad_perm:[1,0,3,2] row_mask:0xf bank_mask:0xf
    v_mov_b32_dpp v63, v61 quad_perm:[1,0,3,2] row_mask:0xf bank_mask:0xf

    s_nop 1
    v_mfma_f32_16x16x32_bf16 v[96:99], v[60:63], v[64:67], 0
    v_mfma_f32_16x16x32_bf16 v[100:103], v[60:63], v[68:71], 0
    v_mfma_f32_16x16x32_bf16 v[104:107], v[60:63], v[72:75], 0
    v_mfma_f32_16x16x32_bf16 v[108:111], v[60:63], v[76:79], 0
    v_mfma_f32_16x16x32_bf16 v[112:115], v[60:63], v[80:83], 0
    v_mfma_f32_16x16x32_bf16 v[116:119], v[60:63], v[84:87], 0
    v_mfma_f32_16x16x32_bf16 v[120:123], v[60:63], v[88:91], 0
    v_mfma_f32_16x16x32_bf16 v[124:127], v[60:63], v[92:95], 0
    s_nop 0
    v_and_or_b32 v16, v96, v15, s7
    v_and_or_b32 v17, v100, v15, s7
    v_and_or_b32 v18, v104, v15, s7
    v_and_or_b32 v19, v108, v15, s7
    s_mov_b64 exec, 0xffff
    buffer_store_dwordx4 v[16:19], v6, s[40:43], s58 offen sc1
    v_and_or_b32 v20, v112, v15, s7
    v_and_or_b32 v21, v116, v15, s7
    v_and_or_b32 v22, v120, v15, s7
    v_and_or_b32 v23, v124, v15, s7
    buffer_store_dwordx4 v[20:23], v6, s[40:43], s58 offen offset:256 sc1
    s_mov_b64 exec, -1
    s_endpgm
L_end:
    s_endpgm
L_codeend:

.section .rodata,"a"
.p2align 6
.amdhsa_kernel recurrent_scan__sliding_block_cached__dense_activation_gelu__decode_kernel
  .amdhsa_next_free_vgpr 160
  .amdhsa_next_free_sgpr 96
  .amdhsa_accum_offset 160
  .amdhsa_group_segment_fixed_size 0
  .amdhsa_kernarg_size 104
  .amdhsa_user_sgpr_count 2
  .amdhsa_user_sgpr_kernarg_segment_ptr 1
  .amdhsa_system_sgpr_workgroup_id_x 1
.end_amdhsa_kernel
```
